```python
import torch

def _softmax(x, axis=-1):
    return torch.softmax(x, dim=axis)
def _gelu(x):
    return torch.nn.functional.gelu(x, approximate="tanh")
def _silu(x):
    return torch.nn.functional.silu(x)
def _sigmoid(x):
    return torch.sigmoid(x)
def _layernorm(x, axis=-1, eps=1e-5):
    m = x.mean(dim=axis, keepdim=True)
    v = x.var(dim=axis, keepdim=True, unbiased=False)
    return (x - m) / torch.sqrt(v + eps)
def _scatter_add(tgt, idx, src, axis=0):
    return tgt.clone().index_add_(axis, idx, src)
def _segment_sum(src, seg, n):
    out = torch.zeros((n,) + src.shape[1:], dtype=src.dtype)
    return out.index_add_(0, seg, src)
def _pad(x, pw):
    flat = tuple(v for pair in reversed(pw) for v in pair)
    return torch.nn.functional.pad(x, flat)

kernel_name = 'standalone__linear_kernel_hedgehog__prompt'

def setup_inputs():

    _w = (lambda a: (lambda t: t.to(torch.bfloat16) if t.is_floating_point() else t)(torch.as_tensor(a)))
    B, S, D, H = 1, 2048, 1024, 32
    Dh = D // H
    return {
        "x": _w((lambda *s: torch.randn(*s, dtype=torch.bfloat16) * 0.4)(B, S, D)),
        "wqkv": _w((lambda *s: torch.randn(*s, dtype=torch.bfloat16) * 0.4)(D, 3 * D)),
        "w_phi": _w((lambda *s: torch.randn(*s, dtype=torch.bfloat16) * 0.4)(H, Dh, Dh) * (Dh ** -0.5)),
        "wo": _w((lambda *s: torch.randn(*s, dtype=torch.bfloat16) * 0.05)(D, D)),
    }

def reference(x, wqkv, w_phi, wo):
    B, S, D = x.shape
    H = 32; Dh = D // H
    qkv = (lambda x, *d: x.permute(*d))((x @ wqkv).reshape(B, S, 3, H, Dh), 2, 0, 3, 1, 4)
    q, k, v = qkv[0], qkv[1], qkv[2]
    pq = torch.einsum("bhsd,hdf->bhsf", q, w_phi)
    pk = torch.einsum("bhsd,hdf->bhsf", k, w_phi)
    phi_q = torch.concatenate([_softmax(pq, axis=-1), _softmax(-pq, axis=-1)], axis=-1)
    phi_k = torch.concatenate([_softmax(pk, axis=-1), _softmax(-pk, axis=-1)], axis=-1)
    kv = torch.einsum("bhsf,bhsd->bhfd", phi_k, v)
    z  = torch.einsum("bhsf->bhf", phi_k)
    num = torch.einsum("bhqf,bhfd->bhqd", phi_q, kv)
    den = torch.einsum("bhqf,bhf->bhq", phi_q, z)[..., None] + 1e-6
    o = num / den
    return (lambda x, *d: x.permute(*d))(o, 0, 2, 1, 3).reshape(B, S, D) @ wo
```

```asm
; @launch grid=(256,1,1) block=(512,1,1) lds=163840
.amdgcn_target "amdgcn-amd-amdhsa--gfx950"
.text
.p2align 12
.globl standalone__linear_kernel_hedgehog__prompt_kernel
.p2align 8
.type standalone__linear_kernel_hedgehog__prompt_kernel,@function
standalone__linear_kernel_hedgehog__prompt_kernel:
    s_cmp_ge_u32 s2, 256
    s_cbranch_scc1 L_end
    s_load_dwordx8 s[4:11], s[0:1], 0
    s_load_dwordx2 s[12:13], s[0:1], 32
    s_load_dwordx2 s[14:15], s[0:1], 48
    v_lshrrev_b32 v1, 6, v0
    v_and_b32 v0, 63, v0
    s_and_b32 s51, s2, 1
    v_readfirstlane_b32 s3, v1
    s_nop 0
    s_cmp_lg_u32 s3, 7
    s_cbranch_scc1 L_cp
    s_getpc_b64 s[24:25]
L_pc:
    s_sub_u32 s24, s24, L_pc-standalone__linear_kernel_hedgehog__prompt_kernel
    s_subb_u32 s25, s25, 0
    s_mov_b32 s26, L_last-standalone__linear_kernel_hedgehog__prompt_kernel
    s_mov_b32 s27, 0x20000
    s_lshr_b32 s46, s2, 3
    s_mul_i32 s46, s46, 1024
    v_lshlrev_b32 v1, 6, v0
    v_add_u32 v1, s46, v1
    s_mov_b64 exec, 0xffff
    buffer_load_dword v47, v1, s[24:27], 0 offen
    s_mov_b64 exec, -1
L_cp:
    s_bfe_u32 s52, s2, 0x20001
    s_bfe_u32 s53, s2, 0x30003
    s_lshr_b32 s54, s2, 6
    s_xor_b32 s54, s54, 3
    s_lshl_b32 s48, s51, 3
    s_add_u32 s48, s48, s53
    s_lshl_b32 s49, s52, 2
    s_add_u32 s49, s49, s54
    s_mov_b32 s19, 0x20000
    s_mov_b32 s23, 0x20000
    s_cmp_ge_u32 s3, 4
    s_cbranch_scc1 L_A
    s_add_u32 s50, s51, s52
    s_and_b32 s50, s50, 1
    s_lshl_b32 s50, s50, 1
    s_add_u32 s46, s53, s54
    s_and_b32 s46, s46, 1
    s_add_u32 s50, s50, s46
    s_lshl_b32 s50, s50, 2
    s_lshl_b32 s55, s3, 12
    s_lshl_b32 s56, s3, 11
    v_lshrrev_b32 v3, 3, v0
    v_and_b32 v4, 7, v0
    v_lshrrev_b32 v5, 4, v0
    v_xor_b32 v6, v5, v4
    v_lshlrev_b32_e64 v6, 4, v6
    s_lshl_b32 s46, s3, 16
    v_lshl_add_u32 v6, v3, 11, v6
    v_add_u32 v16, s46, v6
    v_xor_b32 v6, 64, v16
    v_add_u32 v17, 15360, v6
    v_add_u32 v18, 30720, v16
    v_add_u32 v19, 46080, v6
    v_and_b32 v5, 1, v5
    v_lshlrev_b32 v5, 1, v5
    v_xor_b32 v5, v5, v4
    v_lshlrev_b32 v5, 4, v5
    v_mul_u32_u24 v6, 6144, v3
    s_mul_i32 s46, s3, 98304
    s_and_b32 s47, s49, 1
    s_lshl_b32 s47, s47, 7
    s_add_u32 s57, s46, s47
    s_add_u32 s57, s57, 2048
    s_xor_b32 s47, s47, 128
    s_add_u32 s46, s46, s47
    v_add3_u32 v20, v5, v6, s57
    v_add3_u32 v14, v5, v6, s46
    v_xor_b32_e64 v7, 64, v20
    v_add_u32 v21, 48128, v7
    v_add_u32 v22, 2048, v20
    v_add_u32 v23, 2048, v21
    s_lshl_b32 s46, s48, 18
    s_mov_b32 s18, 262144
    s_lshr_b32 s47, s49, 1
    s_lshl_b32 s47, s47, 8
    s_sub_u32 s22, 6291456, s47
    s_lshl_b32 s58, s50, 7
    s_mul_i32 s59, s50, 393216
    s_add_u32 m0, s55, 32768
    s_waitcnt lgkmcnt(0)
    s_add_u32 s16, s4, s46
    s_addc_u32 s17, s5, 0
    s_add_u32 s20, s6, s47
    s_addc_u32 s21, s7, 0
    buffer_load_dwordx4 v16, s[16:19], s58 offen offset:0 lds
    buffer_load_dwordx4 v17, s[16:19], s58 offen offset:1024 lds
    buffer_load_dwordx4 v18, s[16:19], s58 offen offset:2048 lds
    buffer_load_dwordx4 v19, s[16:19], s58 offen offset:3072 lds
    s_add_u32 m0, s56, 81920
    s_nop 0
    buffer_load_dwordx4 v20, s[20:23], s59 offen offset:0 lds
    buffer_load_dwordx4 v21, s[20:23], s59 offen offset:1024 lds
    s_add_u32 m0, s56, 90112
    s_nop 0
    buffer_load_dwordx4 v22, s[20:23], s59 offen offset:0 lds
    buffer_load_dwordx4 v23, s[20:23], s59 offen offset:1024 lds
    s_load_dword s44, s[14:15], 0
    s_xor_b32 s57, s50, 1
    s_add_u32 m0, s55, 0
    s_lshl_b32 s58, s57, 7
    s_mul_i32 s59, s57, 393216
    buffer_load_dwordx4 v16, s[16:19], s58 offen offset:0 lds
    buffer_load_dwordx4 v17, s[16:19], s58 offen offset:1024 lds
    buffer_load_dwordx4 v18, s[16:19], s58 offen offset:2048 lds
    buffer_load_dwordx4 v19, s[16:19], s58 offen offset:3072 lds
    s_add_u32 m0, s56, 49152
    s_nop 0
    buffer_load_dwordx4 v20, s[20:23], s59 offen offset:0 lds
    buffer_load_dwordx4 v21, s[20:23], s59 offen offset:1024 lds
    s_add_u32 m0, s56, 57344
    s_nop 0
    buffer_load_dwordx4 v22, s[20:23], s59 offen offset:0 lds
    buffer_load_dwordx4 v23, s[20:23], s59 offen offset:1024 lds
    v_xor_b32_e64 v7, 64, v14
    v_add_u32 v15, 48128, v7
    s_mov_b32 s31, 0x20000
    s_mov_b32 s35, 0x20000
    s_mov_b32 s39, 0x20000
    s_mov_b32 s28, s14
    s_mov_b32 s29, s15
    s_mov_b32 s30, 0x10000000
    s_bfe_u32 s46, s2, 0x30003
    s_and_b32 s47, s2, 1
    s_lshl_b32 s47, s47, 3
    s_add_u32 s46, s46, s47
    s_lshl_b32 s46, s46, 7
    s_add_u32 s32, s10, s46
    s_addc_u32 s33, s11, 0
    s_sub_u32 s34, 2097152, s46
    s_mov_b32 s36, s12
    s_mov_b32 s37, s13
    s_mov_b32 s38, 4194304
    s_mov_b32 s40, 0x3fb8aa3b
    s_mov_b32 s41, 0x3fb8aa3b
    s_mov_b32 s42, 0xbfb8aa3b
    s_mov_b32 s43, 0xbfb8aa3b
    s_mov_b32 s10, 65536
    s_mov_b32 s11, 0x20000
    v_lshrrev_b32_e64 v1, 4, v0
    v_bfe_u32 v2, v0, 1, 3
    v_xor_b32 v1, v1, v2
    v_lshlrev_b32 v1, 4, v1
    v_and_b32_e64 v2, 15, v0
    v_lshl_add_u32 v10, v2, 7, v1
    v_xor_b32 v11, 64, v10
    v_add_u32 v10, s55, v10
    v_add_u32 v11, s55, v11
    v_lshlrev_b32 v9, 4, v0
    v_lshrrev_b32_e64 v1, 5, v0
    v_bfe_u32 v2, v0, 2, 2
    v_lshl_add_u32 v1, v1, 3, v2
    v_lshlrev_b32_e64 v1, 6, v1
    v_bfe_u32 v2, v0, 4, 1
    v_lshl_add_u32 v1, v2, 5, v1
    v_and_b32_e64 v2, 3, v0
    v_lshl_add_u32 v8, v2, 3, v1
    s_and_b32 s46, s49, 1
    s_lshl_b32 s46, s46, 12
    s_xor_b32 s46, s46, 4096
    s_add_u32 s46, s46, 155648
    v_add_u32 v8, s46, v8
    s_waitcnt lgkmcnt(0)
    s_add_u32 s44, s44, 0x9e3779b9
    s_and_b32 s44, s44, 0xbfffbfff
    s_waitcnt vmcnt(8)
    s_barrier
    ds_read_b128 v[96:99], v10 offset:32768
    ds_read_b128 v[100:103], v10 offset:34816
    ds_read_b128 v[104:107], v11 offset:32768
    ds_read_b128 v[108:111], v11 offset:34816
    s_lshr_b32 s46, s49, 1
    s_lshl_b32 s46, s46, 13
    s_add_u32 s46, s46, s56
    s_add_u32 m0, s56, 155648
    s_nop 0
    buffer_load_dwordx4 v9, s[8:11], s46 offen offset:0 lds
    buffer_load_dwordx4 v9, s[8:11], s46 offen offset:1024 lds
    s_xor_b32 s57, s50, 2
    s_add_u32 m0, s55, 16384
    s_lshl_b32 s58, s57, 7
    s_mul_i32 s59, s57, 393216
    buffer_load_dwordx4 v16, s[16:19], s58 offen offset:0 lds
    buffer_load_dwordx4 v17, s[16:19], s58 offen offset:1024 lds
    buffer_load_dwordx4 v18, s[16:19], s58 offen offset:2048 lds
    buffer_load_dwordx4 v19, s[16:19], s58 offen offset:3072 lds
    s_add_u32 m0, s56, 65536
    s_nop 0
    buffer_load_dwordx4 v20, s[20:23], s59 offen offset:0 lds
    buffer_load_dwordx4 v21, s[20:23], s59 offen offset:1024 lds
    s_add_u32 m0, s56, 73728
    s_nop 0
    buffer_load_dwordx4 v22, s[20:23], s59 offen offset:0 lds
    buffer_load_dwordx4 v23, s[20:23], s59 offen offset:1024 lds
    s_branch L_nret
L_ret:
    s_setpc_b64 s[60:61]
L_nret:
    s_waitcnt vmcnt(10) lgkmcnt(0)
    s_barrier
    ds_read_b128 v[112:115], v10 offset:0
    ds_read_b128 v[116:119], v10 offset:2048
    ds_read_b128 v[120:123], v11 offset:0
    ds_read_b128 v[124:127], v11 offset:2048
    s_xor_b32 s57, s50, 3
    s_add_u32 m0, s55, 32768
    s_lshl_b32 s58, s57, 7
    s_mul_i32 s59, s57, 393216
    buffer_load_dwordx4 v16, s[16:19], s58 offen offset:0 lds
    buffer_load_dwordx4 v17, s[16:19], s58 offen offset:1024 lds
    buffer_load_dwordx4 v18, s[16:19], s58 offen offset:2048 lds
    buffer_load_dwordx4 v19, s[16:19], s58 offen offset:3072 lds
    s_add_u32 m0, s56, 81920
    s_nop 0
    buffer_load_dwordx4 v20, s[20:23], s59 offen offset:0 lds
    buffer_load_dwordx4 v21, s[20:23], s59 offen offset:1024 lds
    s_add_u32 m0, s56, 90112
    s_nop 0
    buffer_load_dwordx4 v22, s[20:23], s59 offen offset:0 lds
    buffer_load_dwordx4 v23, s[20:23], s59 offen offset:1024 lds
    s_and_b32 s46, s2, 0xca
    s_xor_b32 s46, s46, 0x2
    s_or_b32 s46, s46, s3
    s_cbranch_scc1 L_v0
    s_and_b32 s46, s2, 1
    s_bfe_u32 s47, s2, 0x10002
    s_lshl_b32 s47, s47, 1
    s_add_u32 s46, s46, s47
    s_bfe_u32 s47, s2, 0x20004
    s_lshl_b32 s47, s47, 2
    s_add_u32 s46, s46, s47
    s_lshl_b32 s46, s46, 7
    s_add_u32 s46, s46, 475136
    v_lshlrev_b32 v1, 13, v0
    v_mov_b32 v2, -1
    s_mov_b64 exec, 3
    buffer_atomic_swap v2, v1, s[28:31], s46 offen
    s_mov_b64 exec, -1
L_v0:
    s_waitcnt vmcnt(8) lgkmcnt(0)
    s_barrier
    ds_read_b128 v[128:131], v10 offset:16384
    ds_read_b128 v[132:135], v10 offset:18432
    ds_read_b128 v[136:139], v11 offset:16384
    ds_read_b128 v[140:143], v11 offset:18432
    s_xor_b32 s57, s50, 4
    s_add_u32 m0, s55, 0
    s_lshl_b32 s58, s57, 7
    s_mul_i32 s59, s57, 393216
    buffer_load_dwordx4 v16, s[16:19], s58 offen offset:0 lds
    buffer_load_dwordx4 v17, s[16:19], s58 offen offset:1024 lds
    buffer_load_dwordx4 v18, s[16:19], s58 offen offset:2048 lds
    buffer_load_dwordx4 v19, s[16:19], s58 offen offset:3072 lds
    s_add_u32 m0, s56, 49152
    s_nop 0
    buffer_load_dwordx4 v20, s[20:23], s59 offen offset:0 lds
    buffer_load_dwordx4 v21, s[20:23], s59 offen offset:1024 lds
    s_add_u32 m0, s56, 57344
    s_nop 0
    buffer_load_dwordx4 v22, s[20:23], s59 offen offset:0 lds
    buffer_load_dwordx4 v23, s[20:23], s59 offen offset:1024 lds
    s_waitcnt vmcnt(8) lgkmcnt(0)
    s_barrier
    ds_read_b128 v[144:147], v10 offset:32768
    ds_read_b128 v[148:151], v10 offset:34816
    ds_read_b128 v[152:155], v11 offset:32768
    ds_read_b128 v[156:159], v11 offset:34816
    s_xor_b32 s57, s50, 5
    s_add_u32 m0, s55, 16384
    s_lshl_b32 s58, s57, 7
    s_mul_i32 s59, s57, 393216
    buffer_load_dwordx4 v16, s[16:19], s58 offen offset:0 lds
    buffer_load_dwordx4 v17, s[16:19], s58 offen offset:1024 lds
    buffer_load_dwordx4 v18, s[16:19], s58 offen offset:2048 lds
    buffer_load_dwordx4 v19, s[16:19], s58 offen offset:3072 lds
    s_add_u32 m0, s56, 65536
    s_nop 0
    buffer_load_dwordx4 v20, s[20:23], s59 offen offset:0 lds
    buffer_load_dwordx4 v21, s[20:23], s59 offen offset:1024 lds
    s_add_u32 m0, s56, 73728
    s_nop 0
    buffer_load_dwordx4 v22, s[20:23], s59 offen offset:0 lds
    buffer_load_dwordx4 v23, s[20:23], s59 offen offset:1024 lds
    s_waitcnt vmcnt(8) lgkmcnt(0)
    s_barrier
    ds_read_b128 v[160:163], v10 offset:0
    ds_read_b128 v[164:167], v10 offset:2048
    ds_read_b128 v[168:171], v11 offset:0
    ds_read_b128 v[172:175], v11 offset:2048
    s_xor_b32 s57, s50, 6
    s_add_u32 m0, s55, 32768
    s_lshl_b32 s58, s57, 7
    s_mul_i32 s59, s57, 393216
    buffer_load_dwordx4 v16, s[16:19], s58 offen offset:0 lds
    buffer_load_dwordx4 v17, s[16:19], s58 offen offset:1024 lds
    buffer_load_dwordx4 v18, s[16:19], s58 offen offset:2048 lds
    buffer_load_dwordx4 v19, s[16:19], s58 offen offset:3072 lds
    s_add_u32 m0, s56, 81920
    s_nop 0
    buffer_load_dwordx4 v20, s[20:23], s59 offen offset:0 lds
    buffer_load_dwordx4 v21, s[20:23], s59 offen offset:1024 lds
    s_add_u32 m0, s56, 90112
    s_nop 0
    buffer_load_dwordx4 v22, s[20:23], s59 offen offset:0 lds
    buffer_load_dwordx4 v23, s[20:23], s59 offen offset:1024 lds
    s_waitcnt vmcnt(8) lgkmcnt(0)
    s_barrier
    ds_read_b128 v[176:179], v10 offset:16384
    ds_read_b128 v[180:183], v10 offset:18432
    ds_read_b128 v[184:187], v11 offset:16384
    ds_read_b128 v[188:191], v11 offset:18432
    s_xor_b32 s57, s50, 7
    s_add_u32 m0, s55, 0
    s_lshl_b32 s58, s57, 7
    s_mul_i32 s59, s57, 393216
    buffer_load_dwordx4 v16, s[16:19], s58 offen offset:0 lds
    buffer_load_dwordx4 v17, s[16:19], s58 offen offset:1024 lds
    buffer_load_dwordx4 v18, s[16:19], s58 offen offset:2048 lds
    buffer_load_dwordx4 v19, s[16:19], s58 offen offset:3072 lds
    s_add_u32 m0, s56, 49152
    s_nop 0
    buffer_load_dwordx4 v20, s[20:23], s59 offen offset:0 lds
    buffer_load_dwordx4 v21, s[20:23], s59 offen offset:1024 lds
    s_add_u32 m0, s56, 57344
    s_nop 0
    buffer_load_dwordx4 v22, s[20:23], s59 offen offset:0 lds
    buffer_load_dwordx4 v23, s[20:23], s59 offen offset:1024 lds
    s_and_b32 s46, s2, 0xca
    s_xor_b32 s46, s46, 0x2
    s_or_b32 s46, s46, s3
    s_cbranch_scc1 L_v1
    s_and_b32 s46, s2, 1
    s_bfe_u32 s47, s2, 0x10002
    s_lshl_b32 s47, s47, 1
    s_add_u32 s46, s46, s47
    s_bfe_u32 s47, s2, 0x20004
    s_lshl_b32 s47, s47, 2
    s_add_u32 s46, s46, s47
    s_lshl_b32 s47, s46, 7
    s_add_u32 s47, s47, 475136
    s_xor_b32 s45, s47, 0x2000
    s_mov_b32 s60, 0
    s_mov_b32 s61, 0
    s_waitcnt lgkmcnt(0)
    s_load_dword s60, s[14:15], s47
    s_load_dword s61, s[14:15], s45
    s_waitcnt lgkmcnt(1)
    s_lshl_b32 s46, s46, 2
    s_add_u32 s46, s46, 458752
    s_bfe_u32 s47, s2, 0x10002
    s_xor_b32 s47, s47, s44
    v_lshlrev_b32 v1, 6, v0
    s_mov_b64 exec, 3
    s_cmp_lg_u32 s61, 0
    s_cselect_b32 s45, 1, 0
    s_xor_b32 s47, s47, s45
    v_mov_b32 v2, s47
    buffer_atomic_swap v2, v1, s[28:31], s46 offen
    s_mov_b64 exec, -1
    s_waitcnt lgkmcnt(0)
L_v1:
    s_waitcnt vmcnt(8) lgkmcnt(0)
    s_barrier
    ds_read_b128 v[192:195], v10 offset:32768
    ds_read_b128 v[196:199], v10 offset:34816
    ds_read_b128 v[200:203], v11 offset:32768
    ds_read_b128 v[204:207], v11 offset:34816
    s_xor_b32 s57, s50, 8
    s_add_u32 m0, s55, 16384
    s_lshl_b32 s58, s57, 7
    s_mul_i32 s59, s57, 393216
    buffer_load_dwordx4 v16, s[16:19], s58 offen offset:0 lds
    buffer_load_dwordx4 v17, s[16:19], s58 offen offset:1024 lds
    buffer_load_dwordx4 v18, s[16:19], s58 offen offset:2048 lds
    buffer_load_dwordx4 v19, s[16:19], s58 offen offset:3072 lds
    s_add_u32 m0, s56, 65536
    s_nop 0
    buffer_load_dwordx4 v20, s[20:23], s59 offen offset:0 lds
    buffer_load_dwordx4 v21, s[20:23], s59 offen offset:1024 lds
    s_add_u32 m0, s56, 73728
    s_nop 0
    buffer_load_dwordx4 v22, s[20:23], s59 offen offset:0 lds
    buffer_load_dwordx4 v23, s[20:23], s59 offen offset:1024 lds
    s_waitcnt vmcnt(8) lgkmcnt(0)
    s_barrier
    ds_read_b128 v[208:211], v10 offset:0
    ds_read_b128 v[212:215], v10 offset:2048
    ds_read_b128 v[216:219], v11 offset:0
    ds_read_b128 v[220:223], v11 offset:2048
    s_xor_b32 s57, s50, 9
    s_add_u32 m0, s55, 32768
    s_lshl_b32 s58, s57, 7
    s_mul_i32 s59, s57, 393216
    buffer_load_dwordx4 v16, s[16:19], s58 offen offset:0 lds
    buffer_load_dwordx4 v17, s[16:19], s58 offen offset:1024 lds
    buffer_load_dwordx4 v18, s[16:19], s58 offen offset:2048 lds
    buffer_load_dwordx4 v19, s[16:19], s58 offen offset:3072 lds
    s_add_u32 m0, s56, 81920
    s_nop 0
    buffer_load_dwordx4 v20, s[20:23], s59 offen offset:0 lds
    buffer_load_dwordx4 v21, s[20:23], s59 offen offset:1024 lds
    s_add_u32 m0, s56, 90112
    s_nop 0
    buffer_load_dwordx4 v22, s[20:23], s59 offen offset:0 lds
    buffer_load_dwordx4 v23, s[20:23], s59 offen offset:1024 lds
    s_waitcnt vmcnt(8) lgkmcnt(0)
    s_barrier
    ds_read_b128 v[224:227], v10 offset:16384
    ds_read_b128 v[228:231], v10 offset:18432
    ds_read_b128 v[232:235], v11 offset:16384
    ds_read_b128 v[236:239], v11 offset:18432
    s_xor_b32 s57, s50, 10
    s_add_u32 m0, s55, 0
    s_lshl_b32 s58, s57, 7
    s_mul_i32 s59, s57, 393216
    buffer_load_dwordx4 v16, s[16:19], s58 offen offset:0 lds
    buffer_load_dwordx4 v17, s[16:19], s58 offen offset:1024 lds
    buffer_load_dwordx4 v18, s[16:19], s58 offen offset:2048 lds
    buffer_load_dwordx4 v19, s[16:19], s58 offen offset:3072 lds
    s_add_u32 m0, s56, 49152
    s_nop 0
    buffer_load_dwordx4 v20, s[20:23], s59 offen offset:0 lds
    buffer_load_dwordx4 v21, s[20:23], s59 offen offset:1024 lds
    s_add_u32 m0, s56, 57344
    s_nop 0
    buffer_load_dwordx4 v22, s[20:23], s59 offen offset:0 lds
    buffer_load_dwordx4 v23, s[20:23], s59 offen offset:1024 lds
    s_waitcnt vmcnt(8) lgkmcnt(0)
    s_barrier
    ds_read_b128 v[240:243], v10 offset:32768
    ds_read_b128 v[244:247], v10 offset:34816
    ds_read_b128 v[248:251], v11 offset:32768
    ds_read_b128 v[252:255], v11 offset:34816
    s_xor_b32 s57, s50, 11
    s_add_u32 m0, s55, 16384
    s_lshl_b32 s58, s57, 7
    s_mul_i32 s59, s57, 393216
    buffer_load_dwordx4 v16, s[16:19], s58 offen offset:0 lds
    buffer_load_dwordx4 v17, s[16:19], s58 offen offset:1024 lds
    buffer_load_dwordx4 v18, s[16:19], s58 offen offset:2048 lds
    buffer_load_dwordx4 v19, s[16:19], s58 offen offset:3072 lds
    s_add_u32 m0, s56, 65536
    s_nop 0
    buffer_load_dwordx4 v20, s[20:23], s59 offen offset:0 lds
    buffer_load_dwordx4 v21, s[20:23], s59 offen offset:1024 lds
    s_add_u32 m0, s56, 73728
    s_nop 0
    buffer_load_dwordx4 v22, s[20:23], s59 offen offset:0 lds
    buffer_load_dwordx4 v23, s[20:23], s59 offen offset:1024 lds
    s_waitcnt vmcnt(8) lgkmcnt(0)
    s_barrier
    s_xor_b32 s57, s50, 12
    s_add_u32 m0, s55, 32768
    s_lshl_b32 s58, s57, 7
    s_mul_i32 s59, s57, 393216
    buffer_load_dwordx4 v16, s[16:19], s58 offen offset:0 lds
    buffer_load_dwordx4 v17, s[16:19], s58 offen offset:1024 lds
    buffer_load_dwordx4 v18, s[16:19], s58 offen offset:2048 lds
    buffer_load_dwordx4 v19, s[16:19], s58 offen offset:3072 lds
    s_add_u32 m0, s56, 81920
    s_nop 0
    buffer_load_dwordx4 v20, s[20:23], s59 offen offset:0 lds
    buffer_load_dwordx4 v21, s[20:23], s59 offen offset:1024 lds
    s_add_u32 m0, s56, 90112
    s_nop 0
    buffer_load_dwordx4 v22, s[20:23], s59 offen offset:0 lds
    buffer_load_dwordx4 v23, s[20:23], s59 offen offset:1024 lds
    s_waitcnt vmcnt(8)
    s_barrier
    s_xor_b32 s57, s50, 13
    s_add_u32 m0, s55, 0
    s_lshl_b32 s58, s57, 7
    s_mul_i32 s59, s57, 393216
    buffer_load_dwordx4 v16, s[16:19], s58 offen offset:0 lds
    buffer_load_dwordx4 v17, s[16:19], s58 offen offset:1024 lds
    buffer_load_dwordx4 v18, s[16:19], s58 offen offset:2048 lds
    buffer_load_dwordx4 v19, s[16:19], s58 offen offset:3072 lds
    s_add_u32 m0, s56, 49152
    s_nop 0
    buffer_load_dwordx4 v20, s[20:23], s59 offen offset:0 lds
    buffer_load_dwordx4 v21, s[20:23], s59 offen offset:1024 lds
    s_add_u32 m0, s56, 57344
    s_nop 0
    buffer_load_dwordx4 v22, s[20:23], s59 offen offset:0 lds
    buffer_load_dwordx4 v23, s[20:23], s59 offen offset:1024 lds
    s_waitcnt vmcnt(8)
    s_barrier
    s_xor_b32 s57, s50, 14
    s_add_u32 m0, s55, 16384
    s_lshl_b32 s58, s57, 7
    s_mul_i32 s59, s57, 393216
    buffer_load_dwordx4 v16, s[16:19], s58 offen offset:0 lds
    buffer_load_dwordx4 v17, s[16:19], s58 offen offset:1024 lds
    buffer_load_dwordx4 v18, s[16:19], s58 offen offset:2048 lds
    buffer_load_dwordx4 v19, s[16:19], s58 offen offset:3072 lds
    s_add_u32 m0, s56, 65536
    s_nop 0
    buffer_load_dwordx4 v20, s[20:23], s59 offen offset:0 lds
    buffer_load_dwordx4 v21, s[20:23], s59 offen offset:1024 lds
    s_add_u32 m0, s56, 73728
    s_nop 0
    buffer_load_dwordx4 v22, s[20:23], s59 offen offset:0 lds
    buffer_load_dwordx4 v23, s[20:23], s59 offen offset:1024 lds
    s_waitcnt vmcnt(8)
    s_barrier
    s_xor_b32 s57, s50, 15
    s_add_u32 m0, s55, 32768
    s_lshl_b32 s58, s57, 7
    s_mul_i32 s59, s57, 393216
    buffer_load_dwordx4 v16, s[16:19], s58 offen offset:0 lds
    buffer_load_dwordx4 v17, s[16:19], s58 offen offset:1024 lds
    buffer_load_dwordx4 v18, s[16:19], s58 offen offset:2048 lds
    buffer_load_dwordx4 v19, s[16:19], s58 offen offset:3072 lds
    s_add_u32 m0, s56, 81920
    s_nop 0
    buffer_load_dwordx4 v20, s[20:23], s59 offen offset:0 lds
    buffer_load_dwordx4 v21, s[20:23], s59 offen offset:1024 lds
    s_add_u32 m0, s56, 90112
    s_nop 0
    buffer_load_dwordx4 v22, s[20:23], s59 offen offset:0 lds
    buffer_load_dwordx4 v23, s[20:23], s59 offen offset:1024 lds
    v_lshrrev_b32_e64 v3, 4, v0
    v_bfe_u32 v4, v0, 2, 2
    v_lshl_add_u32 v3, v3, 3, v4
    v_lshlrev_b32 v3, 7, v3
    v_and_b32 v4, 3, v0
    v_lshl_add_u32 v3, v4, 3, v3
    v_bfe_u32 v4, v0, 3, 2
    v_lshl_add_u32 v10, v4, 5, v3
    v_add_u32 v10, 98304, v10
    v_xor_b32 v11, 32, v10
    v_xor_b32 v12, 64, v10
    v_xor_b32 v13, 96, v10
    s_lshr_b32 s46, s3, 1
    s_mul_i32 s46, s46, 49152
    s_and_b32 s47, s3, 1
    s_lshl_b32 s47, s47, 13
    s_add_u32 s46, s46, s47
    s_add_u32 s46, s46, 16384
    v_add_u32 v5, s46, v9
    v_and_b32 v3, 15, v0
    v_lshlrev_b32_e64 v6, 4, v3
    v_bfe_u32 v3, v0, 4, 1
    v_lshl_add_u32 v6, v3, 10, v6
    v_lshrrev_b32_e64 v3, 5, v0
    v_lshl_add_u32 v6, v3, 8, v6
    v_lshrrev_b32 v4, 2, v0
    v_lshrrev_b32 v7, 4, v0
    v_xor_b32 v4, v4, v7
    v_and_b32 v4, 1, v4
    v_lshlrev_b32_e64 v3, 4, v3
    v_lshl_add_u32 v7, v4, 8, v3
    v_add_u32 v7, 8192, v7
    s_lshl_b32 s46, s48, 2
    s_add_u32 s46, s46, s3
    s_xor_b32 s47, s49, 1
    s_lshl_b32 s51, s46, 16
    s_lshl_b32 s54, s47, 12
    s_add_u32 s51, s51, s54
    s_and_b32 s54, s51, 0x1fff
    s_lshl_b32 s51, s51, 1
    s_sub_u32 s51, s51, s54
    s_lshr_b32 s54, s51, 8
    s_and_b32 s54, s54, 0x2000
    s_xor_b32 s51, s51, s54
    s_lshr_b32 s53, s2, 2
    s_xor_b32 s53, s53, s2
    s_and_b32 s53, s53, 1
    s_lshl_b32 s53, s53, 13
    s_xor_b32 s51, s51, s53
    s_add_u32 s51, s51, 16777216
    s_lshl_b32 s52, s46, 10
    s_and_b32 s54, s47, 1
    s_lshl_b32 s54, s54, 9
    s_add_u32 s52, s52, s54
    s_lshr_b32 s54, s47, 1
    s_lshl_b32 s54, s54, 2
    s_add_u32 s52, s52, s54
    s_and_b32 s54, s52, 0x1fff
    s_lshl_b32 s52, s52, 1
    s_sub_u32 s52, s52, s54
    s_add_u32 s52, s52, 655360
    s_xor_b32 s52, s52, s53
    s_mov_b32 s53, 0x358637bd
    ds_read_b64_tr_b16 v[16:17], v8 offset:0
    ds_read_b64_tr_b16 v[18:19], v8 offset:256
    ds_read_b64_tr_b16 v[20:21], v8 offset:1024
    ds_read_b64_tr_b16 v[22:23], v8 offset:1280
    ds_read_b64_tr_b16 v[24:25], v8 offset:2048
    ds_read_b64_tr_b16 v[26:27], v8 offset:2304
    ds_read_b64_tr_b16 v[28:29], v8 offset:3072
    ds_read_b64_tr_b16 v[30:31], v8 offset:3328
    s_nop 0
    v_bfe_u32 v7, v0, 1, 1
    v_mul_u32_u24 v7, 576, v7
    v_mov_b32 v1, 288
    v_add_u32 v3, 8192, v3
    v_or_b32 v8, v4, v0
    v_and_b32 v8, 1, v8
    v_cmp_eq_u32 vcc, 1, v8
    s_nop 1
    v_cndmask_b32 v2, v7, v1, vcc
    v_xor_b32 v8, 1, v0
    v_or_b32 v8, v4, v8
    v_and_b32 v8, 1, v8
    v_cmp_eq_u32 vcc, 1, v8
    s_nop 1
    v_cndmask_b32 v8, v7, v1, vcc
    v_add_u32 v7, v2, v3
    v_add_u32 v8, v8, v3
    v_lshrrev_b32 v3, 3, v0
    v_and_b32 v4, 7, v0
    v_lshlrev_b32 v4, 7, v4
    v_lshl_add_u32 v3, v3, 11, v4
    s_lshr_b32 s46, s2, 3
    s_lshl_b32 s46, s46, 16
    s_lshl_b32 s47, s3, 14
    s_add_u32 s46, s46, s47
    s_bfe_u32 s47, s2, 0x30003
    s_lshl_b32 s47, s47, 7
    s_sub_u32 s46, s46, s47
    s_waitcnt vmcnt(8) lgkmcnt(0)
    s_barrier
    s_xor_b32 s57, s50, 0
    s_add_u32 m0, s56, 98304
    s_mul_i32 s59, s57, 393216
    buffer_load_dwordx4 v14, s[20:23], s59 offen offset:0 lds
    buffer_load_dwordx4 v15, s[20:23], s59 offen offset:1024 lds
    s_xor_b32 s57, s50, 1
    s_add_u32 m0, s56, 106496
    s_mul_i32 s59, s57, 393216
    buffer_load_dwordx4 v14, s[20:23], s59 offen offset:0 lds
    buffer_load_dwordx4 v15, s[20:23], s59 offen offset:1024 lds
    s_xor_b32 s57, s50, 2
    s_add_u32 m0, s56, 114688
    s_mul_i32 s59, s57, 393216
    buffer_load_dwordx4 v14, s[20:23], s59 offen offset:0 lds
    buffer_load_dwordx4 v15, s[20:23], s59 offen offset:1024 lds
    s_xor_b32 s57, s50, 3
    s_add_u32 m0, s56, 122880
    s_mul_i32 s59, s57, 393216
    buffer_load_dwordx4 v14, s[20:23], s59 offen offset:0 lds
    buffer_load_dwordx4 v15, s[20:23], s59 offen offset:1024 lds
    s_waitcnt vmcnt(8)
    s_barrier
    s_xor_b32 s57, s50, 10
    s_add_u32 m0, s56, 0
    s_mul_i32 s59, s57, 393216
    buffer_load_dwordx4 v14, s[20:23], s59 offen offset:0 lds
    buffer_load_dwordx4 v15, s[20:23], s59 offen offset:1024 lds
    s_xor_b32 s57, s50, 11
    s_add_u32 m0, s56, 8192
    s_mul_i32 s59, s57, 393216
    buffer_load_dwordx4 v14, s[20:23], s59 offen offset:0 lds
    buffer_load_dwordx4 v15, s[20:23], s59 offen offset:1024 lds
    s_waitcnt vmcnt(10)
    s_barrier
    v_lshlrev_b32 v2, 2, v0
    s_mov_b32 s47, 458752
    s_mov_b32 exec_hi, 0
    buffer_load_dword v2, v2, s[28:31], s47 offen
    s_mov_b32 exec_hi, -1
    s_xor_b32 s57, s50, 12
    s_add_u32 m0, s56, 32768
    s_mul_i32 s59, s57, 393216
    buffer_load_dwordx4 v14, s[20:23], s59 offen offset:0 lds
    buffer_load_dwordx4 v15, s[20:23], s59 offen offset:1024 lds
    s_xor_b32 s57, s50, 13
    s_add_u32 m0, s56, 40960
    s_mul_i32 s59, s57, 393216
    buffer_load_dwordx4 v14, s[20:23], s59 offen offset:0 lds
    buffer_load_dwordx4 v15, s[20:23], s59 offen offset:1024 lds
    s_xor_b32 s57, s50, 4
    s_add_u32 m0, s56, 131072
    s_mul_i32 s59, s57, 393216
    buffer_load_dwordx4 v14, s[20:23], s59 offen offset:0 lds
    buffer_load_dwordx4 v15, s[20:23], s59 offen offset:1024 lds
    s_xor_b32 s57, s50, 14
    s_add_u32 m0, s56, 81920
    s_mul_i32 s59, s57, 393216
    buffer_load_dwordx4 v14, s[20:23], s59 offen offset:0 lds
    buffer_load_dwordx4 v15, s[20:23], s59 offen offset:1024 lds
    s_xor_b32 s57, s50, 5
    s_add_u32 m0, s56, 139264
    s_mul_i32 s59, s57, 393216
    buffer_load_dwordx4 v14, s[20:23], s59 offen offset:0 lds
    buffer_load_dwordx4 v15, s[20:23], s59 offen offset:1024 lds
    s_xor_b32 s57, s50, 15
    s_add_u32 m0, s56, 90112
    s_mul_i32 s59, s57, 393216
    buffer_load_dwordx4 v14, s[20:23], s59 offen offset:0 lds
    buffer_load_dwordx4 v15, s[20:23], s59 offen offset:1024 lds
    s_xor_b32 s57, s50, 6
    s_add_u32 m0, s56, 147456
    s_mul_i32 s59, s57, 393216
    buffer_load_dwordx4 v14, s[20:23], s59 offen offset:0 lds
    buffer_load_dwordx4 v15, s[20:23], s59 offen offset:1024 lds
    s_xor_b32 s57, s50, 7
    s_add_u32 m0, s56, 155648
    s_mul_i32 s59, s57, 393216
    buffer_load_dwordx4 v14, s[20:23], s59 offen offset:0 lds
    buffer_load_dwordx4 v15, s[20:23], s59 offen offset:1024 lds
    buffer_load_dword v1, v3, s[32:35], s46 offen
    s_mov_b64 exec, 0
    s_cmp_lg_u32 s3, 0
    s_cbranch_scc1 L_t16_0
    s_call_b64 s[60:61], L_pad5
L_t16_0:
    s_cmp_lg_u32 s3, 1
    s_cbranch_scc1 L_t16_1
    s_call_b64 s[60:61], L_pad1
L_t16_1:
    s_cmp_lg_u32 s3, 2
    s_cbranch_scc1 L_t16_2
    s_call_b64 s[60:61], L_pad2
L_t16_2:
    s_cmp_lg_u32 s3, 3
    s_cbranch_scc1 L_t16_3
    s_call_b64 s[60:61], L_pad10
L_t16_3:
    s_cmp_lg_u32 s3, 0
    s_cbranch_scc1 L_t16_4
    s_call_b64 s[60:61], L_pad11
L_t16_4:
    s_cmp_lg_u32 s3, 1
    s_cbranch_scc1 L_t16_5
    s_call_b64 s[60:61], L_pad12
L_t16_5:
    s_cmp_lg_u32 s3, 2
    s_cbranch_scc1 L_t16_6
    s_call_b64 s[60:61], L_pad13
L_t16_6:
    s_mov_b64 exec, -1
    s_waitcnt vmcnt(17)
    v_xor_b32 v2, s44, v2
    s_mov_b32 s45, 0
L_vb:
    v_cmp_eq_u32 vcc, 0, v2
    s_nop 0
    s_bcnt1_i32_b32 s1, vcc_lo
    v_cmp_eq_u32 vcc, 1, v2
    s_add_u32 s1, s1, 1
    s_bcnt1_i32_b32 s0, vcc_lo
    s_max_u32 s1, s1, s0
    s_cmp_gt_u32 s1, 16
    s_cbranch_scc1 L_vb_d
    s_add_u32 s45, s45, 1
    s_cmp_ge_u32 s45, 200000
    s_cbranch_scc1 L_vb_d
    s_mov_b32 s46, 458752
    v_lshlrev_b32 v4, 2, v0
    v_mov_b32 v2, 0
    s_mov_b32 exec_hi, 0
    buffer_atomic_or v2, v4, s[28:31], s46 offen sc0
    s_mov_b32 exec_hi, -1
    s_waitcnt vmcnt(0)
    v_xor_b32 v2, s44, v2
    s_branch L_vb
L_vb_d:
    s_lshl_b32 s1, s2, 11
    s_cmp_gt_u32 s0, 16
    s_cselect_b32 s0, 0x2000, 0
    s_and_b32 s1, s1, 0x2000
    s_xor_b32 s0, s0, s1
    s_xor_b32 s51, s51, s0
    s_xor_b32 s52, s52, s0
    ds_read_b64_tr_b16 v[64:65], v10 offset:0
    ds_read_b64_tr_b16 v[66:67], v10 offset:512
    ds_read_b64_tr_b16 v[68:69], v11 offset:0
    ds_read_b64_tr_b16 v[70:71], v11 offset:512
    ds_read_b64_tr_b16 v[72:73], v12 offset:0
    ds_read_b64_tr_b16 v[74:75], v12 offset:512
    ds_read_b64_tr_b16 v[76:77], v13 offset:0
    ds_read_b64_tr_b16 v[78:79], v13 offset:512
    ds_read_b64_tr_b16 v[80:81], v10 offset:4096
    ds_read_b64_tr_b16 v[82:83], v10 offset:4608
    ds_read_b64_tr_b16 v[84:85], v11 offset:4096
    ds_read_b64_tr_b16 v[86:87], v11 offset:4608
    ds_read_b64_tr_b16 v[88:89], v12 offset:4096
    ds_read_b64_tr_b16 v[90:91], v12 offset:4608
    s_waitcnt lgkmcnt(0)
    s_barrier
    v_mfma_f32_16x16x32_bf16 v[32:35], v[64:67], v[96:99], 0
    ds_read_b64_tr_b16 v[92:93], v13 offset:4096
    v_mfma_f32_16x16x32_bf16 v[48:51], v[64:67], v[100:103], 0
    ds_read_b64_tr_b16 v[94:95], v13 offset:4608
    v_mfma_f32_16x16x32_bf16 v[36:39], v[68:71], v[96:99], 0
    ds_read_b64_tr_b16 v[64:65], v10 offset:8192
    v_mfma_f32_16x16x32_bf16 v[52:55], v[68:71], v[100:103], 0
    ds_read_b64_tr_b16 v[66:67], v10 offset:8704
    v_mfma_f32_16x16x32_bf16 v[40:43], v[72:75], v[96:99], 0
    ds_read_b64_tr_b16 v[68:69], v11 offset:8192
    v_mfma_f32_16x16x32_bf16 v[56:59], v[72:75], v[100:103], 0
    ds_read_b64_tr_b16 v[70:71], v11 offset:8704
    v_mfma_f32_16x16x32_bf16 v[44:47], v[76:79], v[96:99], 0
    ds_read_b64_tr_b16 v[72:73], v12 offset:8192
    v_mfma_f32_16x16x32_bf16 v[60:63], v[76:79], v[100:103], 0
    ds_read_b64_tr_b16 v[74:75], v12 offset:8704
    v_mfma_f32_16x16x32_bf16 v[32:35], v[80:83], v[104:107], v[32:35]
    ds_read_b64_tr_b16 v[76:77], v13 offset:8192
    v_mfma_f32_16x16x32_bf16 v[48:51], v[80:83], v[108:111], v[48:51]
    ds_read_b64_tr_b16 v[78:79], v13 offset:8704
    v_mfma_f32_16x16x32_bf16 v[36:39], v[84:87], v[104:107], v[36:39]
    ds_read_b64_tr_b16 v[80:81], v10 offset:12288
    v_mfma_f32_16x16x32_bf16 v[52:55], v[84:87], v[108:111], v[52:55]
    ds_read_b64_tr_b16 v[82:83], v10 offset:12800
    v_mfma_f32_16x16x32_bf16 v[40:43], v[88:91], v[104:107], v[40:43]
    ds_read_b64_tr_b16 v[84:85], v11 offset:12288
    v_mfma_f32_16x16x32_bf16 v[56:59], v[88:91], v[108:111], v[56:59]
    ds_read_b64_tr_b16 v[86:87], v11 offset:12800
    s_waitcnt lgkmcnt(12)
    v_mfma_f32_16x16x32_bf16 v[44:47], v[92:95], v[104:107], v[44:47]
    ds_read_b64_tr_b16 v[88:89], v12 offset:12288
    v_mfma_f32_16x16x32_bf16 v[60:63], v[92:95], v[108:111], v[60:63]
    ds_read_b64_tr_b16 v[90:91], v12 offset:12800
    s_waitcnt lgkmcnt(12)
    v_mfma_f32_16x16x32_bf16 v[32:35], v[64:67], v[112:115], v[32:35]
    ds_read_b64_tr_b16 v[92:93], v13 offset:12288
    v_mfma_f32_16x16x32_bf16 v[48:51], v[64:67], v[116:119], v[48:51]
    ds_read_b64_tr_b16 v[94:95], v13 offset:12800
    s_waitcnt lgkmcnt(12)
    v_mfma_f32_16x16x32_bf16 v[36:39], v[68:71], v[112:115], v[36:39]
    ds_read_b64_tr_b16 v[64:65], v10 offset:16384
    v_mfma_f32_16x16x32_bf16 v[52:55], v[68:71], v[116:119], v[52:55]
    ds_read_b64_tr_b16 v[66:67], v10 offset:16896
    s_waitcnt lgkmcnt(12)
    v_mfma_f32_16x16x32_bf16 v[40:43], v[72:75], v[112:115], v[40:43]
    ds_read_b64_tr_b16 v[68:69], v11 offset:16384
    v_mfma_f32_16x16x32_bf16 v[56:59], v[72:75], v[116:119], v[56:59]
    ds_read_b64_tr_b16 v[70:71], v11 offset:16896
    s_waitcnt lgkmcnt(12)
    v_mfma_f32_16x16x32_bf16 v[44:47], v[76:79], v[112:115], v[44:47]
    ds_read_b64_tr_b16 v[72:73], v12 offset:16384
    v_mfma_f32_16x16x32_bf16 v[60:63], v[76:79], v[116:119], v[60:63]
    ds_read_b64_tr_b16 v[74:75], v12 offset:16896
    s_waitcnt lgkmcnt(12)
    v_mfma_f32_16x16x32_bf16 v[32:35], v[80:83], v[120:123], v[32:35]
    ds_read_b64_tr_b16 v[76:77], v13 offset:16384
    v_mfma_f32_16x16x32_bf16 v[48:51], v[80:83], v[124:127], v[48:51]
    ds_read_b64_tr_b16 v[78:79], v13 offset:16896
    s_waitcnt lgkmcnt(12)
    v_mfma_f32_16x16x32_bf16 v[36:39], v[84:87], v[120:123], v[36:39]
    ds_read_b64_tr_b16 v[80:81], v10 offset:20480
    v_mfma_f32_16x16x32_bf16 v[52:55], v[84:87], v[124:127], v[52:55]
    ds_read_b64_tr_b16 v[82:83], v10 offset:20992
    s_waitcnt lgkmcnt(12)
    v_mfma_f32_16x16x32_bf16 v[40:43], v[88:91], v[120:123], v[40:43]
    ds_read_b64_tr_b16 v[84:85], v11 offset:20480
    v_mfma_f32_16x16x32_bf16 v[56:59], v[88:91], v[124:127], v[56:59]
    ds_read_b64_tr_b16 v[86:87], v11 offset:20992
    s_waitcnt lgkmcnt(12)
    v_mfma_f32_16x16x32_bf16 v[44:47], v[92:95], v[120:123], v[44:47]
    ds_read_b64_tr_b16 v[88:89], v12 offset:20480
    v_mfma_f32_16x16x32_bf16 v[60:63], v[92:95], v[124:127], v[60:63]
    ds_read_b64_tr_b16 v[90:91], v12 offset:20992
    s_waitcnt lgkmcnt(12)
    v_mfma_f32_16x16x32_bf16 v[32:35], v[64:67], v[128:131], v[32:35]
    ds_read_b64_tr_b16 v[92:93], v13 offset:20480
    v_mfma_f32_16x16x32_bf16 v[48:51], v[64:67], v[132:135], v[48:51]
    ds_read_b64_tr_b16 v[94:95], v13 offset:20992
    s_waitcnt lgkmcnt(12)
    v_mfma_f32_16x16x32_bf16 v[36:39], v[68:71], v[128:131], v[36:39]
    ds_read_b64_tr_b16 v[64:65], v10 offset:24576
    v_mfma_f32_16x16x32_bf16 v[52:55], v[68:71], v[132:135], v[52:55]
    ds_read_b64_tr_b16 v[66:67], v10 offset:25088
    s_waitcnt lgkmcnt(12)
    v_mfma_f32_16x16x32_bf16 v[40:43], v[72:75], v[128:131], v[40:43]
    ds_read_b64_tr_b16 v[68:69], v11 offset:24576
    v_mfma_f32_16x16x32_bf16 v[56:59], v[72:75], v[132:135], v[56:59]
    ds_read_b64_tr_b16 v[70:71], v11 offset:25088
    s_waitcnt lgkmcnt(12)
    v_mfma_f32_16x16x32_bf16 v[44:47], v[76:79], v[128:131], v[44:47]
    ds_read_b64_tr_b16 v[72:73], v12 offset:24576
    v_mfma_f32_16x16x32_bf16 v[60:63], v[76:79], v[132:135], v[60:63]
    ds_read_b64_tr_b16 v[74:75], v12 offset:25088
    s_waitcnt lgkmcnt(12)
    v_mfma_f32_16x16x32_bf16 v[32:35], v[80:83], v[136:139], v[32:35]
    ds_read_b64_tr_b16 v[76:77], v13 offset:24576
    v_mfma_f32_16x16x32_bf16 v[48:51], v[80:83], v[140:143], v[48:51]
    ds_read_b64_tr_b16 v[78:79], v13 offset:25088
    s_waitcnt lgkmcnt(12)
    v_mfma_f32_16x16x32_bf16 v[36:39], v[84:87], v[136:139], v[36:39]
    ds_read_b64_tr_b16 v[80:81], v10 offset:28672
    v_mfma_f32_16x16x32_bf16 v[52:55], v[84:87], v[140:143], v[52:55]
    ds_read_b64_tr_b16 v[82:83], v10 offset:29184
    s_waitcnt lgkmcnt(12)
    v_mfma_f32_16x16x32_bf16 v[40:43], v[88:91], v[136:139], v[40:43]
    ds_read_b64_tr_b16 v[84:85], v11 offset:28672
    v_mfma_f32_16x16x32_bf16 v[56:59], v[88:91], v[140:143], v[56:59]
    ds_read_b64_tr_b16 v[86:87], v11 offset:29184
    s_waitcnt lgkmcnt(12)
    v_mfma_f32_16x16x32_bf16 v[44:47], v[92:95], v[136:139], v[44:47]
    ds_read_b64_tr_b16 v[88:89], v12 offset:28672
    v_mfma_f32_16x16x32_bf16 v[60:63], v[92:95], v[140:143], v[60:63]
    ds_read_b64_tr_b16 v[90:91], v12 offset:29184
    s_waitcnt lgkmcnt(12)
    v_mfma_f32_16x16x32_bf16 v[32:35], v[64:67], v[144:147], v[32:35]
    ds_read_b64_tr_b16 v[92:93], v13 offset:28672
    v_mfma_f32_16x16x32_bf16 v[48:51], v[64:67], v[148:151], v[48:51]
    ds_read_b64_tr_b16 v[94:95], v13 offset:29184
    s_waitcnt lgkmcnt(12)
    v_mfma_f32_16x16x32_bf16 v[36:39], v[68:71], v[144:147], v[36:39]
    s_waitcnt vmcnt(1)
    s_barrier
    s_xor_b32 s57, s50, 8
    s_add_u32 m0, s56, 49152
    s_mul_i32 s59, s57, 393216
    buffer_load_dwordx4 v14, s[20:23], s59 offen offset:0 lds
    buffer_load_dwordx4 v15, s[20:23], s59 offen offset:1024 lds
    s_xor_b32 s57, s50, 9
    s_add_u32 m0, s56, 57344
    s_mul_i32 s59, s57, 393216
    buffer_load_dwordx4 v14, s[20:23], s59 offen offset:0 lds
    buffer_load_dwordx4 v15, s[20:23], s59 offen offset:1024 lds
    ds_read_b64_tr_b16 v[64:65], v10 offset:32768
    v_mfma_f32_16x16x32_bf16 v[52:55], v[68:71], v[148:151], v[52:55]
    ds_read_b64_tr_b16 v[66:67], v10 offset:33280
    s_waitcnt lgkmcnt(12)
    v_mfma_f32_16x16x32_bf16 v[40:43], v[72:75], v[144:147], v[40:43]
    ds_read_b64_tr_b16 v[68:69], v11 offset:32768
    v_mfma_f32_16x16x32_bf16 v[56:59], v[72:75], v[148:151], v[56:59]
    ds_read_b64_tr_b16 v[70:71], v11 offset:33280
    s_waitcnt lgkmcnt(12)
    v_mfma_f32_16x16x32_bf16 v[44:47], v[76:79], v[144:147], v[44:47]
    ds_read_b64_tr_b16 v[72:73], v12 offset:32768
    v_mfma_f32_16x16x32_bf16 v[60:63], v[76:79], v[148:151], v[60:63]
    ds_read_b64_tr_b16 v[74:75], v12 offset:33280
    s_waitcnt lgkmcnt(12)
    v_mfma_f32_16x16x32_bf16 v[32:35], v[80:83], v[152:155], v[32:35]
    ds_read_b64_tr_b16 v[76:77], v13 offset:32768
    v_mfma_f32_16x16x32_bf16 v[48:51], v[80:83], v[156:159], v[48:51]
    ds_read_b64_tr_b16 v[78:79], v13 offset:33280
    s_waitcnt lgkmcnt(12)
    v_mfma_f32_16x16x32_bf16 v[36:39], v[84:87], v[152:155], v[36:39]
    ds_read_b64_tr_b16 v[80:81], v10 offset:36864
    v_mfma_f32_16x16x32_bf16 v[52:55], v[84:87], v[156:159], v[52:55]
    ds_read_b64_tr_b16 v[82:83], v10 offset:37376
    s_waitcnt lgkmcnt(12)
    v_mfma_f32_16x16x32_bf16 v[40:43], v[88:91], v[152:155], v[40:43]
    ds_read_b64_tr_b16 v[84:85], v11 offset:36864
    v_mfma_f32_16x16x32_bf16 v[56:59], v[88:91], v[156:159], v[56:59]
    ds_read_b64_tr_b16 v[86:87], v11 offset:37376
    s_waitcnt lgkmcnt(12)
    v_mfma_f32_16x16x32_bf16 v[44:47], v[92:95], v[152:155], v[44:47]
    ds_read_b64_tr_b16 v[88:89], v12 offset:36864
    v_mfma_f32_16x16x32_bf16 v[60:63], v[92:95], v[156:159], v[60:63]
    ds_read_b64_tr_b16 v[90:91], v12 offset:37376
    s_waitcnt lgkmcnt(12)
    v_mfma_f32_16x16x32_bf16 v[32:35], v[64:67], v[160:163], v[32:35]
    ds_read_b64_tr_b16 v[92:93], v13 offset:36864
    v_mfma_f32_16x16x32_bf16 v[48:51], v[64:67], v[164:167], v[48:51]
    ds_read_b64_tr_b16 v[94:95], v13 offset:37376
    s_waitcnt lgkmcnt(12)
    v_mfma_f32_16x16x32_bf16 v[36:39], v[68:71], v[160:163], v[36:39]
    ds_read_b64_tr_b16 v[64:65], v10 offset:40960
    v_mfma_f32_16x16x32_bf16 v[52:55], v[68:71], v[164:167], v[52:55]
    ds_read_b64_tr_b16 v[66:67], v10 offset:41472
    s_waitcnt lgkmcnt(12)
    v_mfma_f32_16x16x32_bf16 v[40:43], v[72:75], v[160:163], v[40:43]
    ds_read_b64_tr_b16 v[68:69], v11 offset:40960
    v_mfma_f32_16x16x32_bf16 v[56:59], v[72:75], v[164:167], v[56:59]
    ds_read_b64_tr_b16 v[70:71], v11 offset:41472
    s_waitcnt lgkmcnt(12)
    v_mfma_f32_16x16x32_bf16 v[44:47], v[76:79], v[160:163], v[44:47]
    ds_read_b64_tr_b16 v[72:73], v12 offset:40960
    v_mfma_f32_16x16x32_bf16 v[60:63], v[76:79], v[164:167], v[60:63]
    ds_read_b64_tr_b16 v[74:75], v12 offset:41472
    s_waitcnt lgkmcnt(12)
    v_mfma_f32_16x16x32_bf16 v[32:35], v[80:83], v[168:171], v[32:35]
    ds_read_b64_tr_b16 v[76:77], v13 offset:40960
    v_mfma_f32_16x16x32_bf16 v[48:51], v[80:83], v[172:175], v[48:51]
    ds_read_b64_tr_b16 v[78:79], v13 offset:41472
    s_waitcnt lgkmcnt(12)
    v_mfma_f32_16x16x32_bf16 v[36:39], v[84:87], v[168:171], v[36:39]
    ds_read_b64_tr_b16 v[80:81], v10 offset:45056
    v_mfma_f32_16x16x32_bf16 v[52:55], v[84:87], v[172:175], v[52:55]
    ds_read_b64_tr_b16 v[82:83], v10 offset:45568
    s_waitcnt lgkmcnt(12)
    v_mfma_f32_16x16x32_bf16 v[40:43], v[88:91], v[168:171], v[40:43]
    ds_read_b64_tr_b16 v[84:85], v11 offset:45056
    v_mfma_f32_16x16x32_bf16 v[56:59], v[88:91], v[172:175], v[56:59]
    ds_read_b64_tr_b16 v[86:87], v11 offset:45568
    s_waitcnt lgkmcnt(12)
    v_mfma_f32_16x16x32_bf16 v[44:47], v[92:95], v[168:171], v[44:47]
    ds_read_b64_tr_b16 v[88:89], v12 offset:45056
    v_mfma_f32_16x16x32_bf16 v[60:63], v[92:95], v[172:175], v[60:63]
    ds_read_b64_tr_b16 v[90:91], v12 offset:45568
    s_waitcnt lgkmcnt(12)
    v_mfma_f32_16x16x32_bf16 v[32:35], v[64:67], v[176:179], v[32:35]
    ds_read_b64_tr_b16 v[92:93], v13 offset:45056
    v_mfma_f32_16x16x32_bf16 v[48:51], v[64:67], v[180:183], v[48:51]
    ds_read_b64_tr_b16 v[94:95], v13 offset:45568
    s_waitcnt lgkmcnt(12)
    v_mfma_f32_16x16x32_bf16 v[36:39], v[68:71], v[176:179], v[36:39]
    ds_read_b64_tr_b16 v[64:65], v10 offset:49152
    v_mfma_f32_16x16x32_bf16 v[52:55], v[68:71], v[180:183], v[52:55]
    ds_read_b64_tr_b16 v[66:67], v10 offset:49664
    s_waitcnt lgkmcnt(12)
    v_mfma_f32_16x16x32_bf16 v[40:43], v[72:75], v[176:179], v[40:43]
    ds_read_b64_tr_b16 v[68:69], v11 offset:49152
    v_mfma_f32_16x16x32_bf16 v[56:59], v[72:75], v[180:183], v[56:59]
    ds_read_b64_tr_b16 v[70:71], v11 offset:49664
    s_waitcnt lgkmcnt(12)
    v_mfma_f32_16x16x32_bf16 v[44:47], v[76:79], v[176:179], v[44:47]
    ds_read_b64_tr_b16 v[72:73], v12 offset:49152
    v_mfma_f32_16x16x32_bf16 v[60:63], v[76:79], v[180:183], v[60:63]
    ds_read_b64_tr_b16 v[74:75], v12 offset:49664
    s_waitcnt lgkmcnt(12)
    v_mfma_f32_16x16x32_bf16 v[32:35], v[80:83], v[184:187], v[32:35]
    ds_read_b64_tr_b16 v[76:77], v13 offset:49152
    v_mfma_f32_16x16x32_bf16 v[48:51], v[80:83], v[188:191], v[48:51]
    ds_read_b64_tr_b16 v[78:79], v13 offset:49664
    s_waitcnt lgkmcnt(12)
    v_mfma_f32_16x16x32_bf16 v[36:39], v[84:87], v[184:187], v[36:39]
    ds_read_b64_tr_b16 v[80:81], v10 offset:53248
    v_mfma_f32_16x16x32_bf16 v[52:55], v[84:87], v[188:191], v[52:55]
    ds_read_b64_tr_b16 v[82:83], v10 offset:53760
    s_waitcnt lgkmcnt(12)
    v_mfma_f32_16x16x32_bf16 v[40:43], v[88:91], v[184:187], v[40:43]
    ds_read_b64_tr_b16 v[84:85], v11 offset:53248
    v_mfma_f32_16x16x32_bf16 v[56:59], v[88:91], v[188:191], v[56:59]
    ds_read_b64_tr_b16 v[86:87], v11 offset:53760
    s_waitcnt lgkmcnt(12)
    v_mfma_f32_16x16x32_bf16 v[44:47], v[92:95], v[184:187], v[44:47]
    ds_read_b64_tr_b16 v[88:89], v12 offset:53248
    v_mfma_f32_16x16x32_bf16 v[60:63], v[92:95], v[188:191], v[60:63]
    ds_read_b64_tr_b16 v[90:91], v12 offset:53760
    s_waitcnt lgkmcnt(12)
    v_mfma_f32_16x16x32_bf16 v[32:35], v[64:67], v[192:195], v[32:35]
    ds_read_b64_tr_b16 v[92:93], v13 offset:53248
    v_mfma_f32_16x16x32_bf16 v[48:51], v[64:67], v[196:199], v[48:51]
    ds_read_b64_tr_b16 v[94:95], v13 offset:53760
    s_waitcnt lgkmcnt(12)
    v_mfma_f32_16x16x32_bf16 v[36:39], v[68:71], v[192:195], v[36:39]
    ds_read_b64_tr_b16 v[64:65], v10 offset:57344
    v_mfma_f32_16x16x32_bf16 v[52:55], v[68:71], v[196:199], v[52:55]
    ds_read_b64_tr_b16 v[66:67], v10 offset:57856
    s_waitcnt lgkmcnt(12)
    v_mfma_f32_16x16x32_bf16 v[40:43], v[72:75], v[192:195], v[40:43]
    ds_read_b64_tr_b16 v[68:69], v11 offset:57344
    v_mfma_f32_16x16x32_bf16 v[56:59], v[72:75], v[196:199], v[56:59]
    ds_read_b64_tr_b16 v[70:71], v11 offset:57856
    s_waitcnt lgkmcnt(12)
    v_mfma_f32_16x16x32_bf16 v[44:47], v[76:79], v[192:195], v[44:47]
    ds_read_b64_tr_b16 v[72:73], v12 offset:57344
    v_mfma_f32_16x16x32_bf16 v[60:63], v[76:79], v[196:199], v[60:63]
    ds_read_b64_tr_b16 v[74:75], v12 offset:57856
    s_waitcnt lgkmcnt(12)
    v_mfma_f32_16x16x32_bf16 v[32:35], v[80:83], v[200:203], v[32:35]
    ds_read_b64_tr_b16 v[76:77], v13 offset:57344
    v_mfma_f32_16x16x32_bf16 v[48:51], v[80:83], v[204:207], v[48:51]
    ds_read_b64_tr_b16 v[78:79], v13 offset:57856
    s_waitcnt lgkmcnt(12)
    v_mfma_f32_16x16x32_bf16 v[36:39], v[84:87], v[200:203], v[36:39]
    ds_read_b64_tr_b16 v[80:81], v10 offset:61440
    v_mfma_f32_16x16x32_bf16 v[52:55], v[84:87], v[204:207], v[52:55]
    ds_read_b64_tr_b16 v[82:83], v10 offset:61952
    s_waitcnt lgkmcnt(12)
    v_mfma_f32_16x16x32_bf16 v[40:43], v[88:91], v[200:203], v[40:43]
    ds_read_b64_tr_b16 v[84:85], v11 offset:61440
    v_mfma_f32_16x16x32_bf16 v[56:59], v[88:91], v[204:207], v[56:59]
    ds_read_b64_tr_b16 v[86:87], v11 offset:61952
    s_waitcnt lgkmcnt(12)
    v_mfma_f32_16x16x32_bf16 v[44:47], v[92:95], v[200:203], v[44:47]
    ds_read_b64_tr_b16 v[88:89], v12 offset:61440
    v_mfma_f32_16x16x32_bf16 v[60:63], v[92:95], v[204:207], v[60:63]
    ds_read_b64_tr_b16 v[90:91], v12 offset:61952
    s_waitcnt lgkmcnt(12)
    v_mfma_f32_16x16x32_bf16 v[32:35], v[64:67], v[208:211], v[32:35]
    ds_read_b64_tr_b16 v[92:93], v13 offset:61440
    v_mfma_f32_16x16x32_bf16 v[48:51], v[64:67], v[212:215], v[48:51]
    ds_read_b64_tr_b16 v[94:95], v13 offset:61952
    s_waitcnt lgkmcnt(12)
    v_mfma_f32_16x16x32_bf16 v[36:39], v[68:71], v[208:211], v[36:39]
    s_waitcnt vmcnt(0)
    s_barrier
    v_subrev_u32 v10, 49152, v10
    v_subrev_u32 v11, 49152, v11
    v_subrev_u32 v12, 49152, v12
    v_subrev_u32 v13, 49152, v13
    ds_read_b64_tr_b16 v[64:65], v10 offset:0
    v_mfma_f32_16x16x32_bf16 v[52:55], v[68:71], v[212:215], v[52:55]
    ds_read_b64_tr_b16 v[66:67], v10 offset:512
    s_waitcnt lgkmcnt(12)
    v_mfma_f32_16x16x32_bf16 v[40:43], v[72:75], v[208:211], v[40:43]
    ds_read_b64_tr_b16 v[68:69], v11 offset:0
    v_mfma_f32_16x16x32_bf16 v[56:59], v[72:75], v[212:215], v[56:59]
    ds_read_b64_tr_b16 v[70:71], v11 offset:512
    s_waitcnt lgkmcnt(12)
    v_mfma_f32_16x16x32_bf16 v[44:47], v[76:79], v[208:211], v[44:47]
    ds_read_b64_tr_b16 v[72:73], v12 offset:0
    v_mfma_f32_16x16x32_bf16 v[60:63], v[76:79], v[212:215], v[60:63]
    ds_read_b64_tr_b16 v[74:75], v12 offset:512
    s_waitcnt lgkmcnt(12)
    v_mfma_f32_16x16x32_bf16 v[32:35], v[80:83], v[216:219], v[32:35]
    ds_read_b64_tr_b16 v[76:77], v13 offset:0
    v_mfma_f32_16x16x32_bf16 v[48:51], v[80:83], v[220:223], v[48:51]
    ds_read_b64_tr_b16 v[78:79], v13 offset:512
    s_waitcnt lgkmcnt(12)
    v_mfma_f32_16x16x32_bf16 v[36:39], v[84:87], v[216:219], v[36:39]
    ds_read_b64_tr_b16 v[80:81], v10 offset:4096
    v_mfma_f32_16x16x32_bf16 v[52:55], v[84:87], v[220:223], v[52:55]
    ds_read_b64_tr_b16 v[82:83], v10 offset:4608
    s_waitcnt lgkmcnt(12)
    v_mfma_f32_16x16x32_bf16 v[40:43], v[88:91], v[216:219], v[40:43]
    ds_read_b64_tr_b16 v[84:85], v11 offset:4096
    v_mfma_f32_16x16x32_bf16 v[56:59], v[88:91], v[220:223], v[56:59]
    ds_read_b64_tr_b16 v[86:87], v11 offset:4608
    s_waitcnt lgkmcnt(12)
    v_mfma_f32_16x16x32_bf16 v[44:47], v[92:95], v[216:219], v[44:47]
    ds_read_b64_tr_b16 v[88:89], v12 offset:4096
    v_mfma_f32_16x16x32_bf16 v[60:63], v[92:95], v[220:223], v[60:63]
    ds_read_b64_tr_b16 v[90:91], v12 offset:4608
    s_waitcnt lgkmcnt(12)
    v_mfma_f32_16x16x32_bf16 v[32:35], v[64:67], v[224:227], v[32:35]
    ds_read_b64_tr_b16 v[92:93], v13 offset:4096
    v_mfma_f32_16x16x32_bf16 v[48:51], v[64:67], v[228:231], v[48:51]
    ds_read_b64_tr_b16 v[94:95], v13 offset:4608
    s_waitcnt lgkmcnt(12)
    v_mfma_f32_16x16x32_bf16 v[36:39], v[68:71], v[224:227], v[36:39]
    ds_read_b64_tr_b16 v[64:65], v10 offset:8192
    v_mfma_f32_16x16x32_bf16 v[52:55], v[68:71], v[228:231], v[52:55]
    ds_read_b64_tr_b16 v[66:67], v10 offset:8704
    s_waitcnt lgkmcnt(12)
    v_mfma_f32_16x16x32_bf16 v[40:43], v[72:75], v[224:227], v[40:43]
    ds_read_b64_tr_b16 v[68:69], v11 offset:8192
    v_mfma_f32_16x16x32_bf16 v[56:59], v[72:75], v[228:231], v[56:59]
    ds_read_b64_tr_b16 v[70:71], v11 offset:8704
    s_waitcnt lgkmcnt(12)
    v_mfma_f32_16x16x32_bf16 v[44:47], v[76:79], v[224:227], v[44:47]
    ds_read_b64_tr_b16 v[72:73], v12 offset:8192
    v_mfma_f32_16x16x32_bf16 v[60:63], v[76:79], v[228:231], v[60:63]
    ds_read_b64_tr_b16 v[74:75], v12 offset:8704
    s_waitcnt lgkmcnt(12)
    v_mfma_f32_16x16x32_bf16 v[32:35], v[80:83], v[232:235], v[32:35]
    ds_read_b64_tr_b16 v[76:77], v13 offset:8192
    v_mfma_f32_16x16x32_bf16 v[48:51], v[80:83], v[236:239], v[48:51]
    ds_read_b64_tr_b16 v[78:79], v13 offset:8704
    s_waitcnt lgkmcnt(12)
    v_mfma_f32_16x16x32_bf16 v[36:39], v[84:87], v[232:235], v[36:39]
    s_barrier
    ds_read_b128 v[96:99], v5 offset:0
    ds_read_b64_tr_b16 v[80:81], v10 offset:12288
    v_mfma_f32_16x16x32_bf16 v[52:55], v[84:87], v[236:239], v[52:55]
    ds_read_b64_tr_b16 v[82:83], v10 offset:12800
    s_waitcnt lgkmcnt(13)
    v_mfma_f32_16x16x32_bf16 v[40:43], v[88:91], v[232:235], v[40:43]
    ds_read_b128 v[100:103], v5 offset:1024
L_pad1:
    s_cbranch_execz L_ret
    s_nop 0
    ds_read_b64_tr_b16 v[84:85], v11 offset:12288
    v_mfma_f32_16x16x32_bf16 v[56:59], v[88:91], v[236:239], v[56:59]
    ds_read_b64_tr_b16 v[86:87], v11 offset:12800
    s_waitcnt lgkmcnt(14)
    v_mfma_f32_16x16x32_bf16 v[44:47], v[92:95], v[232:235], v[44:47]
    ds_read_b128 v[104:107], v5 offset:2048
    ds_read_b64_tr_b16 v[88:89], v12 offset:12288
    v_mfma_f32_16x16x32_bf16 v[60:63], v[92:95], v[236:239], v[60:63]
    ds_read_b64_tr_b16 v[90:91], v12 offset:12800
    s_waitcnt lgkmcnt(15)
    v_mfma_f32_16x16x32_bf16 v[32:35], v[64:67], v[240:243], v[32:35]
    ds_read_b128 v[108:111], v5 offset:3072
    ds_read_b64_tr_b16 v[92:93], v13 offset:12288
    v_mfma_f32_16x16x32_bf16 v[48:51], v[64:67], v[244:247], v[48:51]
    ds_read_b64_tr_b16 v[94:95], v13 offset:12800
    s_waitcnt lgkmcnt(15)
    v_mfma_f32_16x16x32_bf16 v[36:39], v[68:71], v[240:243], v[36:39]
    ds_read_b128 v[112:115], v5 offset:4096
    v_mfma_f32_16x16x32_bf16 v[52:55], v[68:71], v[244:247], v[52:55]
    s_waitcnt lgkmcnt(15)
    v_mfma_f32_16x16x32_bf16 v[40:43], v[72:75], v[240:243], v[40:43]
    ds_read_b128 v[116:119], v5 offset:5120
    v_mfma_f32_16x16x32_bf16 v[56:59], v[72:75], v[244:247], v[56:59]
    s_waitcnt lgkmcnt(14)
    v_mfma_f32_16x16x32_bf16 v[44:47], v[76:79], v[240:243], v[44:47]
    ds_read_b128 v[120:123], v5 offset:6144
    v_mfma_f32_16x16x32_bf16 v[60:63], v[76:79], v[244:247], v[60:63]
    s_waitcnt lgkmcnt(12)
    v_mfma_f32_16x16x32_bf16 v[32:35], v[80:83], v[248:251], v[32:35]
    ds_read_b128 v[124:127], v5 offset:7168
    v_mfma_f32_16x16x32_bf16 v[48:51], v[80:83], v[252:255], v[48:51]
    s_waitcnt lgkmcnt(10)
    v_mfma_f32_16x16x32_bf16 v[36:39], v[84:87], v[248:251], v[36:39]
    v_mfma_f32_16x16x32_bf16 v[52:55], v[84:87], v[252:255], v[52:55]
    s_waitcnt lgkmcnt(7)
    v_mfma_f32_16x16x32_bf16 v[40:43], v[88:91], v[248:251], v[40:43]
    v_mfma_f32_16x16x32_bf16 v[56:59], v[88:91], v[252:255], v[56:59]
    s_waitcnt lgkmcnt(4)
    v_mfma_f32_16x16x32_bf16 v[44:47], v[92:95], v[248:251], v[44:47]
    v_mfma_f32_16x16x32_bf16 v[60:63], v[92:95], v[252:255], v[60:63]
    s_nop 0
    v_pk_add_f32 v[32:33], v[32:33], v[96:97]
    v_pk_add_f32 v[34:35], v[34:35], v[98:99]
    s_nop 0
    s_waitcnt lgkmcnt(3)
    v_pk_add_f32 v[48:49], v[48:49], v[112:113]
    v_pk_add_f32 v[50:51], v[50:51], v[114:115]
    v_pk_add_f32 v[36:37], v[36:37], v[100:101]
    v_pk_add_f32 v[38:39], v[38:39], v[102:103]
    s_nop 0
    s_waitcnt lgkmcnt(2)
    v_pk_add_f32 v[52:53], v[52:53], v[116:117]
    v_pk_add_f32 v[54:55], v[54:55], v[118:119]
    v_pk_add_f32 v[40:41], v[40:41], v[104:105]
    v_pk_add_f32 v[42:43], v[42:43], v[106:107]
    s_nop 0
    s_waitcnt lgkmcnt(1)
    v_pk_add_f32 v[56:57], v[56:57], v[120:121]
    v_pk_add_f32 v[58:59], v[58:59], v[122:123]
    v_pk_add_f32 v[44:45], v[44:45], v[108:109]
    v_pk_add_f32 v[46:47], v[46:47], v[110:111]
    s_nop 0
    s_waitcnt lgkmcnt(0)
    v_pk_add_f32 v[60:61], v[60:61], v[124:125]
    v_pk_add_f32 v[62:63], v[62:63], v[126:127]
    v_cvt_pk_bf16_f32 v64, v32, v33
    v_cvt_pk_bf16_f32 v72, v40, v41
    v_cvt_pk_bf16_f32 v65, v34, v35
    v_cvt_pk_bf16_f32 v73, v42, v43
    v_cvt_pk_bf16_f32 v66, v48, v49
    v_cvt_pk_bf16_f32 v74, v56, v57
    v_cvt_pk_bf16_f32 v67, v50, v51
    v_cvt_pk_bf16_f32 v75, v58, v59
    v_cvt_pk_bf16_f32 v68, v36, v37
    v_cvt_pk_bf16_f32 v76, v44, v45
    v_cvt_pk_bf16_f32 v69, v38, v39
    v_cvt_pk_bf16_f32 v77, v46, v47
    v_cvt_pk_bf16_f32 v70, v52, v53
    v_cvt_pk_bf16_f32 v78, v60, v61
    v_cvt_pk_bf16_f32 v71, v54, v55
    v_cvt_pk_bf16_f32 v79, v62, v63
    v_permlane16_swap_b32 v64, v66
    v_permlane16_swap_b32 v72, v74
    v_permlane16_swap_b32 v65, v67
    v_permlane16_swap_b32 v73, v75
    v_permlane16_swap_b32 v68, v70
    v_permlane16_swap_b32 v76, v78
    v_permlane16_swap_b32 v69, v71
    v_permlane16_swap_b32 v77, v79
    v_mfma_f32_32x32x16_bf16 v[160:175], v[16:19], v[64:67], 0
    v_mfma_f32_32x32x16_bf16 v[192:207], v[24:27], v[72:75], 0
    v_mfma_f32_32x32x16_bf16 v[160:175], v[20:23], v[68:71], v[160:175]
    v_mfma_f32_32x32x16_bf16 v[192:207], v[28:31], v[76:79], v[192:207]
    s_nop 0
    s_nop 10
    v_max3_f32 v80, v160, v161, v162
    v_max3_f32 v84, v192, v193, v194
    v_max3_f32 v82, -v160, -v161, -v162
    v_max3_f32 v86, -v192, -v193, -v194
    v_max3_f32 v80, v80, v163, v164
    v_max3_f32 v84, v84, v195, v196
    v_max3_f32 v82, v82, -v163, -v164
    v_max3_f32 v86, v86, -v195, -v196
    v_max3_f32 v80, v80, v165, v166
    v_max3_f32 v84, v84, v197, v198
    v_max3_f32 v82, v82, -v165, -v166
    v_max3_f32 v86, v86, -v197, -v198
    v_max3_f32 v80, v80, v167, v168
    v_max3_f32 v84, v84, v199, v200
    v_max3_f32 v82, v82, -v167, -v168
    v_max3_f32 v86, v86, -v199, -v200
    v_max3_f32 v80, v80, v169, v170
    v_max3_f32 v84, v84, v201, v202
    v_max3_f32 v82, v82, -v169, -v170
    v_max3_f32 v86, v86, -v201, -v202
    v_max3_f32 v80, v80, v171, v172
    v_max3_f32 v84, v84, v203, v204
    v_max3_f32 v82, v82, -v171, -v172
    v_max3_f32 v86, v86, -v203, -v204
    v_max3_f32 v80, v80, v173, v174
    v_max3_f32 v84, v84, v205, v206
    v_max3_f32 v82, v82, -v173, -v174
    v_max3_f32 v86, v86, -v205, -v206
    v_max_f32 v80, v80, v175
    v_max_f32 v84, v84, v207
    v_max_f32_e64 v82, v82, -v175
    v_max_f32_e64 v86, v86, -v207
    s_nop 0
    v_permlane32_swap_b32 v80, v82
    v_permlane32_swap_b32 v84, v86
    v_max_f32 v80, v80, v82
    v_max_f32 v84, v84, v86
    v_mul_f32 v82, s42, v80
    v_mul_f32 v86, s42, v84
    v_mul_f32 v80, s42, v80
    v_mul_f32 v84, s42, v84
    s_nop 0
    v_permlane32_swap_b32 v80, v82
    v_permlane32_swap_b32 v84, v86
    v_pk_fma_f32 v[176:177], v[160:161], s[42:43], v[82:83] op_sel_hi:[1,1,0]
    v_pk_fma_f32 v[208:209], v[192:193], s[42:43], v[86:87] op_sel_hi:[1,1,0]
    v_pk_fma_f32 v[160:161], v[160:161], s[40:41], v[80:81] op_sel_hi:[1,1,0]
    v_pk_fma_f32 v[192:193], v[192:193], s[40:41], v[84:85] op_sel_hi:[1,1,0]
    v_pk_fma_f32 v[178:179], v[162:163], s[42:43], v[82:83] op_sel_hi:[1,1,0]
    v_pk_fma_f32 v[210:211], v[194:195], s[42:43], v[86:87] op_sel_hi:[1,1,0]
    v_pk_fma_f32 v[162:163], v[162:163], s[40:41], v[80:81] op_sel_hi:[1,1,0]
    v_pk_fma_f32 v[194:195], v[194:195], s[40:41], v[84:85] op_sel_hi:[1,1,0]
    v_pk_fma_f32 v[180:181], v[164:165], s[42:43], v[82:83] op_sel_hi:[1,1,0]
    v_pk_fma_f32 v[212:213], v[196:197], s[42:43], v[86:87] op_sel_hi:[1,1,0]
    v_pk_fma_f32 v[164:165], v[164:165], s[40:41], v[80:81] op_sel_hi:[1,1,0]
    v_pk_fma_f32 v[196:197], v[196:197], s[40:41], v[84:85] op_sel_hi:[1,1,0]
    v_pk_fma_f32 v[182:183], v[166:167], s[42:43], v[82:83] op_sel_hi:[1,1,0]
    v_pk_fma_f32 v[214:215], v[198:199], s[42:43], v[86:87] op_sel_hi:[1,1,0]
    v_pk_fma_f32 v[166:167], v[166:167], s[40:41], v[80:81] op_sel_hi:[1,1,0]
    v_pk_fma_f32 v[198:199], v[198:199], s[40:41], v[84:85] op_sel_hi:[1,1,0]
    v_pk_fma_f32 v[184:185], v[168:169], s[42:43], v[82:83] op_sel_hi:[1,1,0]
    v_pk_fma_f32 v[216:217], v[200:201], s[42:43], v[86:87] op_sel_hi:[1,1,0]
    v_pk_fma_f32 v[168:169], v[168:169], s[40:41], v[80:81] op_sel_hi:[1,1,0]
    v_pk_fma_f32 v[200:201], v[200:201], s[40:41], v[84:85] op_sel_hi:[1,1,0]
    v_pk_fma_f32 v[186:187], v[170:171], s[42:43], v[82:83] op_sel_hi:[1,1,0]
    v_pk_fma_f32 v[218:219], v[202:203], s[42:43], v[86:87] op_sel_hi:[1,1,0]
    v_pk_fma_f32 v[170:171], v[170:171], s[40:41], v[80:81] op_sel_hi:[1,1,0]
    v_pk_fma_f32 v[202:203], v[202:203], s[40:41], v[84:85] op_sel_hi:[1,1,0]
    v_pk_fma_f32 v[188:189], v[172:173], s[42:43], v[82:83] op_sel_hi:[1,1,0]
    v_pk_fma_f32 v[220:221], v[204:205], s[42:43], v[86:87] op_sel_hi:[1,1,0]
    v_pk_fma_f32 v[172:173], v[172:173], s[40:41], v[80:81] op_sel_hi:[1,1,0]
    v_pk_fma_f32 v[204:205], v[204:205], s[40:41], v[84:85] op_sel_hi:[1,1,0]
    v_pk_fma_f32 v[190:191], v[174:175], s[42:43], v[82:83] op_sel_hi:[1,1,0]
    v_pk_fma_f32 v[222:223], v[206:207], s[42:43], v[86:87] op_sel_hi:[1,1,0]
    v_pk_fma_f32 v[174:175], v[174:175], s[40:41], v[80:81] op_sel_hi:[1,1,0]
    v_pk_fma_f32 v[206:207], v[206:207], s[40:41], v[84:85] op_sel_hi:[1,1,0]
    v_exp_f32 v160, v160
    v_exp_f32 v161, v161
    v_exp_f32 v162, v162
    v_exp_f32 v163, v163
    v_exp_f32 v164, v164
    v_exp_f32 v165, v165
    v_exp_f32 v166, v166
    v_exp_f32 v167, v167
    v_exp_f32 v176, v176
    v_exp_f32 v177, v177
    v_cvt_pk_bf16_f32 v96, v160, v161
    v_exp_f32 v178, v178
    v_exp_f32 v179, v179
    v_cvt_pk_bf16_f32 v97, v162, v163
    v_exp_f32 v180, v180
    v_exp_f32 v181, v181
    v_cvt_pk_bf16_f32 v98, v164, v165
    v_exp_f32 v182, v182
    v_exp_f32 v183, v183
    v_cvt_pk_bf16_f32 v99, v166, v167
    v_exp_f32 v168, v168
    v_exp_f32 v169, v169
    v_cvt_pk_bf16_f32 v104, v176, v177
    v_exp_f32 v170, v170
    v_exp_f32 v171, v171
    v_cvt_pk_bf16_f32 v105, v178, v179
    v_exp_f32 v172, v172
    v_exp_f32 v173, v173
    v_cvt_pk_bf16_f32 v106, v180, v181
    v_exp_f32 v174, v174
    v_exp_f32 v175, v175
    v_cvt_pk_bf16_f32 v107, v182, v183
    v_exp_f32 v184, v184
    s_barrier
    ds_read_b128 v[16:19], v7 offset:0
    v_exp_f32 v185, v185
    ds_read_b128 v[128:131], v9 offset:0
    s_nop 0
    v_cvt_pk_bf16_f32 v100, v168, v169
    ds_read_b128 v[24:27], v8 offset:64
    v_exp_f32 v186, v186
    ds_read_b128 v[136:139], v9 offset:2048
    v_exp_f32 v187, v187
    ds_read_b128 v[20:23], v7 offset:32
    v_cvt_pk_bf16_f32 v101, v170, v171
    ds_read_b128 v[132:135], v9 offset:1024
    v_exp_f32 v188, v188
    ds_read_b128 v[28:31], v8 offset:96
    v_exp_f32 v189, v189
    ds_read_b128 v[140:143], v9 offset:3072
    v_cvt_pk_bf16_f32 v102, v172, v173
    ds_read_b128 v[64:67], v7 offset:128
    v_exp_f32 v190, v190
    ds_read_b128 v[144:147], v9 offset:4096
    v_exp_f32 v191, v191
    ds_read_b128 v[72:75], v8 offset:192
    v_cvt_pk_bf16_f32 v103, v174, v175
    ds_read_b128 v[152:155], v9 offset:6144
    v_exp_f32 v192, v192
    ds_read_b128 v[68:71], v7 offset:160
    v_exp_f32 v193, v193
    ds_read_b128 v[148:151], v9 offset:5120
    v_cvt_pk_bf16_f32 v108, v184, v185
    ds_read_b128 v[76:79], v8 offset:224
    v_exp_f32 v194, v194
    ds_read_b128 v[156:159], v9 offset:7168
    v_exp_f32 v195, v195
    v_cvt_pk_bf16_f32 v109, v186, v187
    s_waitcnt lgkmcnt(15)
    v_mfma_f32_16x16x32_bf16 v[88:91], v[16:19], v[96:99], 0
    v_exp_f32 v196, v196
    s_waitcnt lgkmcnt(14)
    v_mfma_f32_32x32x16_bf16 v[32:47], v[128:131], v[96:99], 0
    v_exp_f32 v197, v197
    s_waitcnt lgkmcnt(13)
    v_mfma_f32_16x16x32_bf16 v[88:91], v[24:27], v[104:107], v[88:91]
    s_nop 0
    v_cvt_pk_bf16_f32 v110, v188, v189
    s_waitcnt lgkmcnt(12)
    v_mfma_f32_32x32x16_bf16 v[224:239], v[136:139], v[104:107], 0
    v_exp_f32 v198, v198
    s_waitcnt lgkmcnt(11)
    v_mfma_f32_16x16x32_bf16 v[88:91], v[20:23], v[100:103], v[88:91]
    v_exp_f32 v199, v199
    s_waitcnt lgkmcnt(10)
    v_mfma_f32_32x32x16_bf16 v[32:47], v[132:135], v[100:103], v[32:47]
    s_nop 0
    v_cvt_pk_bf16_f32 v111, v190, v191
    v_exp_f32 v208, v208
    v_exp_f32 v209, v209
    s_waitcnt lgkmcnt(9)
    v_mfma_f32_16x16x32_bf16 v[88:91], v[28:31], v[108:111], v[88:91]
    s_nop 0
    v_cvt_pk_bf16_f32 v112, v192, v193
    s_waitcnt lgkmcnt(8)
    v_mfma_f32_32x32x16_bf16 v[224:239], v[140:143], v[108:111], v[224:239]
    v_exp_f32 v210, v210
    v_exp_f32_e64 v211, v211
    v_cvt_pk_bf16_f32 v113, v194, v195
    v_exp_f32 v212, v212
    v_exp_f32 v213, v213
    v_cvt_pk_bf16_f32 v114, v196, v197
    v_fma_f32 v88, s53, v90, v88
    v_exp_f32 v214, v214
    v_mul_f32 v89, v89, v90
    v_exp_f32_e64 v215, v215
    v_fma_f32 v88, v88, v91, v89
    v_cvt_pk_bf16_f32 v115, v198, v199
    v_rcp_f32 v88, v88
    v_exp_f32 v200, v200
    v_pk_mul_f32 v[90:91], v[90:91], v[88:89] op_sel_hi:[1,0]
    v_exp_f32 v201, v201
    s_waitcnt lgkmcnt(7)
    v_mfma_f32_16x16x32_bf16 v[92:95], v[64:67], v[112:115], 0
    v_cvt_pk_bf16_f32 v120, v208, v209
    s_waitcnt lgkmcnt(6)
    v_mfma_f32_32x32x16_bf16 v[48:63], v[144:147], v[112:115], 0
    v_exp_f32 v202, v202
    v_pk_mul_f32 v[32:33], v[32:33], v[90:91] op_sel:[0,1] op_sel_hi:[1,1]
    v_exp_f32_e64 v203, v203
    v_pk_mul_f32 v[34:35], v[34:35], v[90:91] op_sel:[0,1] op_sel_hi:[1,1]
    v_cvt_pk_bf16_f32 v121, v210, v211
    v_pk_mul_f32 v[36:37], v[36:37], v[90:91] op_sel:[0,1] op_sel_hi:[1,1]
    v_exp_f32_e64 v204, v204
    v_pk_mul_f32 v[38:39], v[38:39], v[90:91] op_sel:[0,1] op_sel_hi:[1,1]
    v_exp_f32_e64 v205, v205
    v_pk_mul_f32 v[40:41], v[40:41], v[90:91] op_sel:[0,1] op_sel_hi:[1,1]
    v_cvt_pk_bf16_f32 v122, v212, v213
    v_pk_mul_f32 v[42:43], v[42:43], v[90:91] op_sel:[0,1] op_sel_hi:[1,1]
    v_exp_f32_e64 v206, v206
    v_pk_mul_f32 v[44:45], v[44:45], v[90:91] op_sel:[0,1] op_sel_hi:[1,1]
    v_exp_f32_e64 v207, v207
    v_pk_mul_f32 v[46:47], v[46:47], v[90:91] op_sel:[0,1] op_sel_hi:[1,1]
    v_cvt_pk_bf16_f32 v123, v214, v215
    v_pk_fma_f32 v[32:33], v[224:225], v[90:91], v[32:33] op_sel_hi:[1,0,1]
    v_exp_f32_e64 v216, v216
    v_pk_fma_f32 v[34:35], v[226:227], v[90:91], v[34:35] op_sel_hi:[1,0,1]
    v_exp_f32 v217, v217
    s_waitcnt lgkmcnt(5)
    v_mfma_f32_16x16x32_bf16 v[92:95], v[72:75], v[120:123], v[92:95]
    v_cvt_pk_bf16_f32 v116, v200, v201
    s_waitcnt lgkmcnt(4)
    v_mfma_f32_32x32x16_bf16 v[240:255], v[152:155], v[120:123], 0
    v_exp_f32 v218, v218
    v_pk_fma_f32 v[36:37], v[228:229], v[90:91], v[36:37] op_sel_hi:[1,0,1]
    v_exp_f32_e64 v219, v219
    v_pk_fma_f32 v[38:39], v[230:231], v[90:91], v[38:39] op_sel_hi:[1,0,1]
    v_cvt_pk_bf16_f32 v117, v202, v203
    v_cvt_pk_bf16_f32 v160, v32, v33
    v_exp_f32_e64 v220, v220
    v_cvt_pk_bf16_f32 v161, v34, v35
    v_exp_f32_e64 v221, v221
    v_cvt_pk_bf16_f32 v162, v36, v37
    v_cvt_pk_bf16_f32 v118, v204, v205
    v_cvt_pk_bf16_f32 v163, v38, v39
    v_exp_f32 v222, v222
    buffer_store_dwordx4 v[160:163], v6, s[28:31], s51 offen offset:0 sc1
    v_exp_f32 v223, v223
    v_pk_fma_f32 v[40:41], v[232:233], v[90:91], v[40:41] op_sel_hi:[1,0,1]
    v_cvt_pk_bf16_f32 v119, v206, v207
    v_pk_fma_f32 v[42:43], v[234:235], v[90:91], v[42:43] op_sel_hi:[1,0,1]
    v_cvt_pk_bf16_f32 v124, v216, v217
    v_pk_fma_f32 v[44:45], v[236:237], v[90:91], v[44:45] op_sel_hi:[1,0,1]
    v_cvt_pk_bf16_f32 v125, v218, v219
    s_waitcnt lgkmcnt(3)
    v_mfma_f32_16x16x32_bf16 v[92:95], v[68:71], v[116:119], v[92:95]
    s_nop 0
    v_cvt_pk_bf16_f32 v126, v220, v221
    s_waitcnt lgkmcnt(2)
    v_mfma_f32_32x32x16_bf16 v[48:63], v[148:151], v[116:119], v[48:63]
    s_nop 0
    v_cvt_pk_bf16_f32 v127, v222, v223
    v_pk_fma_f32 v[46:47], v[238:239], v[90:91], v[46:47] op_sel_hi:[1,0,1]
    v_mov_b32_e64 v3, s44
    v_cvt_pk_bf16_f32 v164, v40, v41
    v_lshlrev_b32 v4, 7, v0
    s_waitcnt lgkmcnt(1)
    v_mfma_f32_16x16x32_bf16 v[92:95], v[76:79], v[124:127], v[92:95]
    s_waitcnt lgkmcnt(0)
    v_mfma_f32_32x32x16_bf16 v[240:255], v[156:159], v[124:127], v[240:255]
    s_nop 0
    v_cvt_pk_bf16_f32 v165, v42, v43
    v_cvt_pk_bf16_f32 v166, v44, v45
    v_cvt_pk_bf16_f32 v167, v46, v47
    buffer_store_dwordx4 v[164:167], v6, s[28:31], s51 offen offset:512 sc1
    s_nop 0
    s_nop 1
    v_fma_f32 v92, s53, v94, v92
    v_mul_f32_e64 v93, v93, v94
    v_fma_f32 v92, v92, v95, v93
    v_rcp_f32 v92, v92
    s_nop 0
    v_pk_mul_f32 v[94:95], v[94:95], v[92:93] op_sel_hi:[1,0]
    v_pk_mul_f32 v[48:49], v[48:49], v[94:95] op_sel:[0,1] op_sel_hi:[1,1]
    v_pk_mul_f32 v[50:51], v[50:51], v[94:95] op_sel:[0,1] op_sel_hi:[1,1]
    v_pk_mul_f32 v[52:53], v[52:53], v[94:95] op_sel:[0,1] op_sel_hi:[1,1]
    v_pk_mul_f32 v[54:55], v[54:55], v[94:95] op_sel:[0,1] op_sel_hi:[1,1]
    v_pk_mul_f32 v[56:57], v[56:57], v[94:95] op_sel:[0,1] op_sel_hi:[1,1]
    v_pk_mul_f32 v[58:59], v[58:59], v[94:95] op_sel:[0,1] op_sel_hi:[1,1]
    v_pk_mul_f32 v[60:61], v[60:61], v[94:95] op_sel:[0,1] op_sel_hi:[1,1]
    v_pk_mul_f32 v[62:63], v[62:63], v[94:95] op_sel:[0,1] op_sel_hi:[1,1]
    v_pk_fma_f32 v[48:49], v[240:241], v[94:95], v[48:49] op_sel_hi:[1,0,1]
    v_pk_fma_f32 v[50:51], v[242:243], v[94:95], v[50:51] op_sel_hi:[1,0,1]
    v_pk_fma_f32 v[52:53], v[244:245], v[94:95], v[52:53] op_sel_hi:[1,0,1]
    v_pk_fma_f32 v[54:55], v[246:247], v[94:95], v[54:55] op_sel_hi:[1,0,1]
    v_cvt_pk_bf16_f32 v168, v48, v49
    v_cvt_pk_bf16_f32 v169, v50, v51
    v_cvt_pk_bf16_f32 v170, v52, v53
    v_cvt_pk_bf16_f32 v171, v54, v55
    buffer_store_dwordx4 v[168:171], v6, s[28:31], s51 offen offset:2048 sc1
    v_pk_fma_f32 v[56:57], v[248:249], v[94:95], v[56:57] op_sel_hi:[1,0,1]
    v_pk_fma_f32 v[58:59], v[250:251], v[94:95], v[58:59] op_sel_hi:[1,0,1]
    v_pk_fma_f32 v[60:61], v[252:253], v[94:95], v[60:61] op_sel_hi:[1,0,1]
    v_pk_fma_f32 v[62:63], v[254:255], v[94:95], v[62:63] op_sel_hi:[1,0,1]
    v_cvt_pk_bf16_f32 v172, v56, v57
    v_cvt_pk_bf16_f32 v173, v58, v59
    v_cvt_pk_bf16_f32 v174, v60, v61
    v_cvt_pk_bf16_f32 v175, v62, v63
    buffer_store_dwordx4 v[172:175], v6, s[28:31], s51 offen offset:2560 sc1
    s_barrier
    s_mov_b32 s47, 1
L_G2:
L_pad12:
    s_cbranch_execz L_ret
    s_nop 0
    s_mov_b32 s40, s52
    s_and_b32 s43, s2, 6
    s_lshl_b32 s43, s43, 1
    s_lshr_b32 s46, s2, 6
    s_add_u32 s43, s43, s46
    s_lshl_b32 s46, s43, 2
    s_add_u32 s46, s46, s3
    s_lshl_b32 s58, s46, 10
    s_lshl_b32 s27, s47, 9
    s_add_u32 s58, s58, s27
    s_lshr_b32 s57, s2, 6
    s_lshl_b32 s57, s57, 1
    s_bfe_u32 s27, s2, 0x20003
    s_lshl_b32 s27, s27, 7
    s_add_u32 s58, s58, s27
    s_and_b32 s27, s58, 0x1fff
    s_lshl_b32 s58, s58, 1
    s_sub_u32 s58, s58, s27
    s_xor_b32 s58, s58, s0
    s_add_u32 s58, s58, 655360
    s_load_dwordx8 s[48:55], s[14:15], s58 glc
    s_lshl_b32 s59, s46, 17
    s_lshl_b32 s27, s47, 12
    s_add_u32 s59, s59, s27
    s_lshr_b32 s27, s59, 8
    s_and_b32 s27, s27, 0x2000
    s_xor_b32 s59, s59, s27
    s_xor_b32 s59, s59, s0
    s_add_u32 s59, s59, 16777216
    s_lshl_b32 s27, s47, 10
    v_add_u32_e64 v10, s27, v9
    v_xor_b32 v11, 1024, v10
    v_lshrrev_b32_e64 v1, 5, v0
    v_bfe_u32 v2, v0, 2, 3
    v_lshl_add_u32 v1, v1, 4, v2
    v_lshlrev_b32_e64 v1, 7, v1
    v_bfe_u32 v2, v0, 3, 2
    v_lshl_add_u32 v1, v2, 5, v1
    v_and_b32_e64 v2, 3, v0
    v_lshl_add_u32 v1, v2, 3, v1
    s_lshl_b32 s27, s47, 13
    s_add_u32 s27, s27, 32768
    v_add_u32 v26, s27, v1
    s_lshl_b32 s27, s3, 1
    s_add_u32 s27, s27, s47
    s_lshl_b32 s41, s27, 12
    v_add_u32 v18, s41, v9
    v_xor_b32 v19, 4096, v18
    s_lshl_b32 s41, s43, 18
    s_lshl_b32 s27, s27, 15
    s_add_u32 s41, s41, s27
    s_bfe_u32 s27, s2, 0x30003
    s_and_b32 s46, s2, 1
    s_lshl_b32 s46, s46, 3
    s_add_u32 s27, s27, s46
    s_lshl_b32 s27, s27, 7
    s_add_u32 s41, s41, s27
    v_lshrrev_b32 v1, 3, v0
    v_and_b32 v2, 7, v0
    v_lshlrev_b32_e64 v20, 11, v1
    v_lshl_add_u32 v20, v2, 4, v20
    v_add_u32 v21, 0x4000, v20
    s_lshl_b32 s46, s3, 13
    v_lshlrev_b32 v1, 4, v1
    v_xor_b32 v29, v1, v9
    v_add_u32 v29, s46, v29
    v_bfe_u32 v1, v0, 4, 1
    v_lshrrev_b32_e64 v27, 5, v0
    v_lshl_add_u32 v1, v1, 1, v27
    v_xor_b32 v1, v1, v2
    v_and_b32 v2, 15, v0
    v_lshlrev_b32_e64 v2, 7, v2
    v_lshl_add_u32 v27, v1, 4, v2
    v_add_u32 v27, s46, v27
    v_xor_b32 v28, 64, v27
    s_mov_b32 s24, 0
    s_mov_b32 s25, 0xff
    s_mov_b32 s1, s47
    s_cmp_lg_u32 s47, 0
    s_cbranch_scc1 L_G2B
    s_waitcnt vmcnt(0)
    s_load_dwordx8 s[48:55], s[14:15], s58 glc
    s_barrier
    s_branch L_G2D
L_G2B:
    s_waitcnt vmcnt(0)
    s_mov_b64 exec, 15
    buffer_atomic_swap v3, v4, s[28:31], s40 offen
    s_mov_b64 exec, -1
    s_mov_b32 s1, 0
L_G2D:
    s_waitcnt lgkmcnt(0)
    s_branch L_G2C
L_pl:
L_pad13:
    s_cbranch_execz L_ret
    s_nop 0
    s_mov_b32 s45, 0
L_pl1:
    s_cmp_eq_u32 s55, s44
    s_addc_u32 s46, s46, s46
    s_cmp_eq_u32 s54, s44
    s_addc_u32 s46, s46, s46
    s_cmp_eq_u32 s53, s44
    s_addc_u32 s46, s46, s46
    s_cmp_eq_u32 s52, s44
    s_addc_u32 s46, s46, s46
    s_cmp_eq_u32 s51, s44
    s_addc_u32 s46, s46, s46
    s_cmp_eq_u32 s50, s44
    s_addc_u32 s46, s46, s46
    s_cmp_eq_u32 s49, s44
    s_addc_u32 s46, s46, s46
    s_cmp_eq_u32 s48, s44
    s_addc_u32 s46, s46, s46
    s_and_b32 s46, s46, 0xff
    s_mul_i32 s46, s46, 0x101
    s_lshr_b32 s46, s46, s57
    s_or_b32 s24, s24, s46
    s_and_b32 s46, s24, s25
    s_cbranch_scc1 L_plr
    s_mov_b32 s46, s25
    s_add_u32 s45, s45, 1
    s_cmp_ge_u32 s45, 200000
    s_cbranch_scc1 L_plr
    s_load_dwordx8 s[48:55], s[14:15], s58 glc
    s_mul_i32 s46, s45, s1
    s_cmp_lt_u32 s46, 1
    s_cbranch_scc1 L_pl2
    s_waitcnt vmcnt(0)
    s_mov_b64 exec, 15
    buffer_atomic_swap v3, v4, s[28:31], s40 offen
    s_mov_b64 exec, -1
    s_mov_b32 s1, 0
L_pl2:
    s_waitcnt lgkmcnt(0)
    s_branch L_pl1
L_plr:
    s_setpc_b64 s[12:13]
L_G2C:
L_pad11:
    s_cbranch_execz L_ret
    s_nop 0
    s_call_b64 s[12:13], L_pl
L_s0_k:
    s_ff1_i32_b32 s27, s46
    s_bitset0_b32 s25, s27
    s_add_u32 s27, s27, s57
    s_and_b32 s27, s27, 7
    s_lshl_b32 s26, s27, 14
    s_add_u32 s42, s59, s26
    v_add_u32 v14, s26, v26
    v_xor_b32 v15, 32, v14
    v_xor_b32_e64 v16, 64, v14
    v_xor_b32 v17, 96, v14
    buffer_load_dwordx4 v[132:135], v11, s[28:31], s42 offen offset:0 sc1
    s_and_b32 s46, s24, s25
    s_cbranch_scc1 L_r0
    s_load_dwordx8 s[48:55], s[14:15], s58 glc
L_r0:
    buffer_load_dwordx4 v[128:131], v10, s[28:31], s42 offen offset:0 sc1
    buffer_load_dwordx4 v[140:143], v11, s[28:31], s42 offen offset:2048 sc1
    buffer_load_dwordx4 v[136:139], v10, s[28:31], s42 offen offset:2048 sc1
    s_and_b32 s46, s24, s25
    s_cbranch_scc1 L_s1_k
    s_call_b64 s[12:13], L_pl
L_s1_k:
    s_ff1_i32_b32 s27, s46
    s_bitset0_b32 s25, s27
    s_add_u32 s27, s27, s57
    s_and_b32 s27, s27, 7
    s_lshl_b32 s26, s27, 14
    s_add_u32 s60, s59, s26
    v_add_u32 v22, s26, v26
    v_xor_b32 v23, 32, v22
    v_xor_b32 v24, 64, v22
    v_xor_b32 v25, 96, v22
    buffer_load_dwordx4 v[148:151], v11, s[28:31], s60 offen offset:0 sc1
    s_and_b32 s46, s24, s25
    s_cbranch_scc1 L_r1
    s_load_dwordx8 s[48:55], s[14:15], s58 glc
L_r1:
    buffer_load_dwordx4 v[144:147], v10, s[28:31], s60 offen offset:0 sc1
    ds_read_b64_tr_b16 v[80:81], v14 offset:0
    ds_read_b64_tr_b16 v[82:83], v14 offset:1024
    ds_read_b64_tr_b16 v[84:85], v15 offset:0
    ds_read_b64_tr_b16 v[86:87], v15 offset:1024
    ds_read_b64_tr_b16 v[88:89], v16 offset:0
    ds_read_b64_tr_b16 v[90:91], v16 offset:1024
    ds_read_b64_tr_b16 v[92:93], v17 offset:0
    ds_read_b64_tr_b16 v[94:95], v17 offset:1024
    ds_read_b64_tr_b16 v[96:97], v14 offset:4096
    ds_read_b64_tr_b16 v[98:99], v14 offset:5120
    ds_read_b64_tr_b16 v[100:101], v15 offset:4096
    ds_read_b64_tr_b16 v[102:103], v15 offset:5120
    ds_read_b64_tr_b16 v[104:105], v16 offset:4096
    ds_read_b64_tr_b16 v[106:107], v16 offset:5120
    s_waitcnt vmcnt(5) lgkmcnt(12)
    v_mfma_f32_16x16x32_bf16 v[64:67], v[80:83], v[132:135], 0
    ds_read_b64_tr_b16 v[108:109], v17 offset:4096
    s_waitcnt vmcnt(4)
    v_mfma_f32_16x16x32_bf16 v[48:51], v[80:83], v[128:131], 0
    ds_read_b64_tr_b16 v[110:111], v17 offset:5120
    buffer_load_dwordx4 v[156:159], v11, s[28:31], s60 offen offset:2048 sc1
    s_waitcnt lgkmcnt(12)
    v_mfma_f32_16x16x32_bf16 v[68:71], v[84:87], v[132:135], 0
    ds_read_b64_tr_b16 v[80:81], v22 offset:0
    v_mfma_f32_16x16x32_bf16 v[52:55], v[84:87], v[128:131], 0
    ds_read_b64_tr_b16 v[82:83], v22 offset:1024
    s_waitcnt lgkmcnt(12)
    v_mfma_f32_16x16x32_bf16 v[72:75], v[88:91], v[132:135], 0
    ds_read_b64_tr_b16 v[84:85], v23 offset:0
    v_mfma_f32_16x16x32_bf16 v[56:59], v[88:91], v[128:131], 0
    ds_read_b64_tr_b16 v[86:87], v23 offset:1024
    buffer_load_dwordx4 v[152:155], v10, s[28:31], s60 offen offset:2048 sc1
    s_waitcnt lgkmcnt(12)
    v_mfma_f32_16x16x32_bf16 v[76:79], v[92:95], v[132:135], 0
    ds_read_b64_tr_b16 v[88:89], v24 offset:0
    v_mfma_f32_16x16x32_bf16 v[60:63], v[92:95], v[128:131], 0
    ds_read_b64_tr_b16 v[90:91], v24 offset:1024
    s_waitcnt vmcnt(5) lgkmcnt(12)
    v_mfma_f32_16x16x32_bf16 v[64:67], v[96:99], v[140:143], v[64:67]
    ds_read_b64_tr_b16 v[92:93], v25 offset:0
    s_waitcnt vmcnt(4)
    v_mfma_f32_16x16x32_bf16 v[48:51], v[96:99], v[136:139], v[48:51]
    ds_read_b64_tr_b16 v[94:95], v25 offset:1024
    s_and_b32 s46, s24, s25
    s_cbranch_scc1 L_s2_k
    s_call_b64 s[12:13], L_pl
L_s2_k:
    s_ff1_i32_b32 s27, s46
    s_bitset0_b32 s25, s27
    s_add_u32 s27, s27, s57
    s_and_b32 s27, s27, 7
    s_lshl_b32 s26, s27, 14
    s_add_u32 s61, s59, s26
    v_add_u32 v14, s26, v26
    v_xor_b32 v15, 32, v14
    v_xor_b32_e64 v16, 64, v14
    v_xor_b32 v17, 96, v14
    buffer_load_dwordx4 v[164:167], v11, s[28:31], s61 offen offset:0 sc1
    s_and_b32 s46, s24, s25
    s_cbranch_scc1 L_r2
    s_load_dwordx8 s[48:55], s[14:15], s58 glc
L_r2:
    s_waitcnt lgkmcnt(12)
    v_mfma_f32_16x16x32_bf16 v[68:71], v[100:103], v[140:143], v[68:71]
    ds_read_b64_tr_b16 v[96:97], v22 offset:4096
    v_mfma_f32_16x16x32_bf16 v[52:55], v[100:103], v[136:139], v[52:55]
    ds_read_b64_tr_b16 v[98:99], v22 offset:5120
    s_waitcnt lgkmcnt(12)
    v_mfma_f32_16x16x32_bf16 v[72:75], v[104:107], v[140:143], v[72:75]
    ds_read_b64_tr_b16 v[100:101], v23 offset:4096
    v_mfma_f32_16x16x32_bf16 v[56:59], v[104:107], v[136:139], v[56:59]
    ds_read_b64_tr_b16 v[102:103], v23 offset:5120
    buffer_load_dwordx4 v[160:163], v10, s[28:31], s61 offen offset:0 sc1
    s_waitcnt lgkmcnt(12)
    v_mfma_f32_16x16x32_bf16 v[76:79], v[108:111], v[140:143], v[76:79]
    ds_read_b64_tr_b16 v[104:105], v24 offset:4096
    v_mfma_f32_16x16x32_bf16 v[60:63], v[108:111], v[136:139], v[60:63]
    ds_read_b64_tr_b16 v[106:107], v24 offset:5120
    s_waitcnt vmcnt(5) lgkmcnt(12)
    v_mfma_f32_16x16x32_bf16 v[64:67], v[80:83], v[148:151], v[64:67]
    ds_read_b64_tr_b16 v[108:109], v25 offset:4096
    s_waitcnt vmcnt(4)
    v_mfma_f32_16x16x32_bf16 v[48:51], v[80:83], v[144:147], v[48:51]
    ds_read_b64_tr_b16 v[110:111], v25 offset:5120
    buffer_load_dwordx4 v[172:175], v11, s[28:31], s61 offen offset:2048 sc1
    s_waitcnt lgkmcnt(12)
    v_mfma_f32_16x16x32_bf16 v[68:71], v[84:87], v[148:151], v[68:71]
    ds_read_b64_tr_b16 v[80:81], v14 offset:0
    v_mfma_f32_16x16x32_bf16 v[52:55], v[84:87], v[144:147], v[52:55]
L_pad2:
    s_cbranch_execz L_ret
    s_nop 0
    ds_read_b64_tr_b16 v[82:83], v14 offset:1024
    s_waitcnt lgkmcnt(12)
    v_mfma_f32_16x16x32_bf16 v[72:75], v[88:91], v[148:151], v[72:75]
    ds_read_b64_tr_b16 v[84:85], v15 offset:0
    v_mfma_f32_16x16x32_bf16 v[56:59], v[88:91], v[144:147], v[56:59]
    ds_read_b64_tr_b16 v[86:87], v15 offset:1024
    buffer_load_dwordx4 v[168:171], v10, s[28:31], s61 offen offset:2048 sc1
    s_waitcnt lgkmcnt(12)
    v_mfma_f32_16x16x32_bf16 v[76:79], v[92:95], v[148:151], v[76:79]
    ds_read_b64_tr_b16 v[88:89], v16 offset:0
    v_mfma_f32_16x16x32_bf16 v[60:63], v[92:95], v[144:147], v[60:63]
    ds_read_b64_tr_b16 v[90:91], v16 offset:1024
    s_waitcnt vmcnt(5) lgkmcnt(12)
    v_mfma_f32_16x16x32_bf16 v[64:67], v[96:99], v[156:159], v[64:67]
    ds_read_b64_tr_b16 v[92:93], v17 offset:0
    s_waitcnt vmcnt(4)
    v_mfma_f32_16x16x32_bf16 v[48:51], v[96:99], v[152:155], v[48:51]
    ds_read_b64_tr_b16 v[94:95], v17 offset:1024
    s_and_b32 s46, s24, s25
    s_cbranch_scc1 L_s3_k
    s_call_b64 s[12:13], L_pl
L_s3_k:
    s_ff1_i32_b32 s27, s46
    s_bitset0_b32 s25, s27
    s_add_u32 s27, s27, s57
    s_and_b32 s27, s27, 7
    s_lshl_b32 s26, s27, 14
    s_add_u32 s42, s59, s26
    v_add_u32 v22, s26, v26
    v_xor_b32 v23, 32, v22
    v_xor_b32 v24, 64, v22
    v_xor_b32 v25, 96, v22
    buffer_load_dwordx4 v[180:183], v11, s[28:31], s42 offen offset:0 sc1
    s_and_b32 s46, s24, s25
    s_cbranch_scc1 L_r3
    s_load_dwordx8 s[48:55], s[14:15], s58 glc
L_r3:
    s_waitcnt lgkmcnt(12)
    v_mfma_f32_16x16x32_bf16 v[68:71], v[100:103], v[156:159], v[68:71]
    ds_read_b64_tr_b16 v[96:97], v14 offset:4096
    v_mfma_f32_16x16x32_bf16 v[52:55], v[100:103], v[152:155], v[52:55]
    ds_read_b64_tr_b16 v[98:99], v14 offset:5120
    s_waitcnt lgkmcnt(12)
    v_mfma_f32_16x16x32_bf16 v[72:75], v[104:107], v[156:159], v[72:75]
    ds_read_b64_tr_b16 v[100:101], v15 offset:4096
    v_mfma_f32_16x16x32_bf16 v[56:59], v[104:107], v[152:155], v[56:59]
    ds_read_b64_tr_b16 v[102:103], v15 offset:5120
    buffer_load_dwordx4 v[176:179], v10, s[28:31], s42 offen offset:0 sc1
    s_waitcnt lgkmcnt(12)
    v_mfma_f32_16x16x32_bf16 v[76:79], v[108:111], v[156:159], v[76:79]
    ds_read_b64_tr_b16 v[104:105], v16 offset:4096
    v_mfma_f32_16x16x32_bf16 v[60:63], v[108:111], v[152:155], v[60:63]
    ds_read_b64_tr_b16 v[106:107], v16 offset:5120
    s_waitcnt vmcnt(5) lgkmcnt(12)
    v_mfma_f32_16x16x32_bf16 v[64:67], v[80:83], v[164:167], v[64:67]
    ds_read_b64_tr_b16 v[108:109], v17 offset:4096
    s_waitcnt vmcnt(4)
    v_mfma_f32_16x16x32_bf16 v[48:51], v[80:83], v[160:163], v[48:51]
    ds_read_b64_tr_b16 v[110:111], v17 offset:5120
    buffer_load_dwordx4 v[188:191], v11, s[28:31], s42 offen offset:2048 sc1
    s_waitcnt lgkmcnt(12)
    v_mfma_f32_16x16x32_bf16 v[68:71], v[84:87], v[164:167], v[68:71]
    ds_read_b64_tr_b16 v[80:81], v22 offset:0
    v_mfma_f32_16x16x32_bf16 v[52:55], v[84:87], v[160:163], v[52:55]
    ds_read_b64_tr_b16 v[82:83], v22 offset:1024
    s_waitcnt lgkmcnt(12)
    v_mfma_f32_16x16x32_bf16 v[72:75], v[88:91], v[164:167], v[72:75]
    ds_read_b64_tr_b16 v[84:85], v23 offset:0
    v_mfma_f32_16x16x32_bf16 v[56:59], v[88:91], v[160:163], v[56:59]
    ds_read_b64_tr_b16 v[86:87], v23 offset:1024
    buffer_load_dwordx4 v[184:187], v10, s[28:31], s42 offen offset:2048 sc1
    s_waitcnt lgkmcnt(12)
    v_mfma_f32_16x16x32_bf16 v[76:79], v[92:95], v[164:167], v[76:79]
    ds_read_b64_tr_b16 v[88:89], v24 offset:0
    v_mfma_f32_16x16x32_bf16 v[60:63], v[92:95], v[160:163], v[60:63]
    ds_read_b64_tr_b16 v[90:91], v24 offset:1024
    s_waitcnt vmcnt(5) lgkmcnt(12)
    v_mfma_f32_16x16x32_bf16 v[64:67], v[96:99], v[172:175], v[64:67]
    ds_read_b64_tr_b16 v[92:93], v25 offset:0
    s_waitcnt vmcnt(4)
    v_mfma_f32_16x16x32_bf16 v[48:51], v[96:99], v[168:171], v[48:51]
    ds_read_b64_tr_b16 v[94:95], v25 offset:1024
    s_and_b32 s46, s24, s25
    s_cbranch_scc1 L_s4_k
    s_call_b64 s[12:13], L_pl
L_s4_k:
    s_ff1_i32_b32 s27, s46
    s_bitset0_b32 s25, s27
    s_add_u32 s27, s27, s57
    s_and_b32 s27, s27, 7
    s_lshl_b32 s26, s27, 14
    s_add_u32 s60, s59, s26
    v_add_u32 v14, s26, v26
    v_xor_b32 v15, 32, v14
    v_xor_b32 v16, 64, v14
    v_xor_b32 v17, 96, v14
    buffer_load_dwordx4 v[196:199], v11, s[28:31], s60 offen offset:0 sc1
    s_and_b32 s46, s24, s25
    s_cbranch_scc1 L_r4
    s_load_dwordx8 s[48:55], s[14:15], s58 glc
L_r4:
    s_waitcnt lgkmcnt(12)
    v_mfma_f32_16x16x32_bf16 v[68:71], v[100:103], v[172:175], v[68:71]
    ds_read_b64_tr_b16 v[96:97], v22 offset:4096
    v_mfma_f32_16x16x32_bf16 v[52:55], v[100:103], v[168:171], v[52:55]
    ds_read_b64_tr_b16 v[98:99], v22 offset:5120
    s_waitcnt lgkmcnt(12)
    v_mfma_f32_16x16x32_bf16 v[72:75], v[104:107], v[172:175], v[72:75]
    ds_read_b64_tr_b16 v[100:101], v23 offset:4096
    v_mfma_f32_16x16x32_bf16 v[56:59], v[104:107], v[168:171], v[56:59]
    ds_read_b64_tr_b16 v[102:103], v23 offset:5120
    buffer_load_dwordx4 v[192:195], v10, s[28:31], s60 offen offset:0 sc1
    s_waitcnt lgkmcnt(12)
    v_mfma_f32_16x16x32_bf16 v[76:79], v[108:111], v[172:175], v[76:79]
    ds_read_b64_tr_b16 v[104:105], v24 offset:4096
    v_mfma_f32_16x16x32_bf16 v[60:63], v[108:111], v[168:171], v[60:63]
    ds_read_b64_tr_b16 v[106:107], v24 offset:5120
    s_waitcnt vmcnt(5) lgkmcnt(12)
    v_mfma_f32_16x16x32_bf16 v[64:67], v[80:83], v[180:183], v[64:67]
    ds_read_b64_tr_b16 v[108:109], v25 offset:4096
    s_waitcnt vmcnt(4)
    v_mfma_f32_16x16x32_bf16 v[48:51], v[80:83], v[176:179], v[48:51]
    ds_read_b64_tr_b16 v[110:111], v25 offset:5120
    buffer_load_dwordx4 v[204:207], v11, s[28:31], s60 offen offset:2048 sc1
    s_waitcnt lgkmcnt(12)
    v_mfma_f32_16x16x32_bf16 v[68:71], v[84:87], v[180:183], v[68:71]
    ds_read_b64_tr_b16 v[80:81], v14 offset:0
    v_mfma_f32_16x16x32_bf16 v[52:55], v[84:87], v[176:179], v[52:55]
    ds_read_b64_tr_b16 v[82:83], v14 offset:1024
    s_waitcnt lgkmcnt(12)
    v_mfma_f32_16x16x32_bf16 v[72:75], v[88:91], v[180:183], v[72:75]
    ds_read_b64_tr_b16 v[84:85], v15 offset:0
    v_mfma_f32_16x16x32_bf16 v[56:59], v[88:91], v[176:179], v[56:59]
    ds_read_b64_tr_b16 v[86:87], v15 offset:1024
    buffer_load_dwordx4 v[200:203], v10, s[28:31], s60 offen offset:2048 sc1
    s_waitcnt lgkmcnt(12)
    v_mfma_f32_16x16x32_bf16 v[76:79], v[92:95], v[180:183], v[76:79]
    ds_read_b64_tr_b16 v[88:89], v16 offset:0
    v_mfma_f32_16x16x32_bf16 v[60:63], v[92:95], v[176:179], v[60:63]
    ds_read_b64_tr_b16 v[90:91], v16 offset:1024
    s_waitcnt vmcnt(5) lgkmcnt(12)
    v_mfma_f32_16x16x32_bf16 v[64:67], v[96:99], v[188:191], v[64:67]
    ds_read_b64_tr_b16 v[92:93], v17 offset:0
    s_waitcnt vmcnt(4)
    v_mfma_f32_16x16x32_bf16 v[48:51], v[96:99], v[184:187], v[48:51]
    ds_read_b64_tr_b16 v[94:95], v17 offset:1024
    s_and_b32 s46, s24, s25
    s_cbranch_scc1 L_s5_k
    s_call_b64 s[12:13], L_pl
L_s5_k:
    s_ff1_i32_b32 s27, s46
    s_bitset0_b32 s25, s27
    s_add_u32 s27, s27, s57
    s_and_b32 s27, s27, 7
    s_lshl_b32 s26, s27, 14
    s_add_u32 s61, s59, s26
    v_add_u32 v22, s26, v26
    v_xor_b32 v23, 32, v22
    v_xor_b32 v24, 64, v22
    v_xor_b32 v25, 96, v22
    buffer_load_dwordx4 v[212:215], v11, s[28:31], s61 offen offset:0 sc1
    s_and_b32 s46, s24, s25
    s_cbranch_scc1 L_r5
    s_load_dwordx8 s[48:55], s[14:15], s58 glc
L_r5:
    s_waitcnt lgkmcnt(12)
    v_mfma_f32_16x16x32_bf16 v[68:71], v[100:103], v[188:191], v[68:71]
    ds_read_b64_tr_b16 v[96:97], v14 offset:4096
    v_mfma_f32_16x16x32_bf16 v[52:55], v[100:103], v[184:187], v[52:55]
    ds_read_b64_tr_b16 v[98:99], v14 offset:5120
    s_waitcnt lgkmcnt(12)
    v_mfma_f32_16x16x32_bf16 v[72:75], v[104:107], v[188:191], v[72:75]
    ds_read_b64_tr_b16 v[100:101], v15 offset:4096
    v_mfma_f32_16x16x32_bf16 v[56:59], v[104:107], v[184:187], v[56:59]
    ds_read_b64_tr_b16 v[102:103], v15 offset:5120
    s_setprio 0
    buffer_load_dwordx4 v[208:211], v10, s[28:31], s61 offen offset:0 sc1
    s_waitcnt lgkmcnt(12)
    v_mfma_f32_16x16x32_bf16 v[76:79], v[108:111], v[188:191], v[76:79]
    ds_read_b64_tr_b16 v[104:105], v16 offset:4096
    v_mfma_f32_16x16x32_bf16 v[60:63], v[108:111], v[184:187], v[60:63]
    ds_read_b64_tr_b16 v[106:107], v16 offset:5120
    s_waitcnt vmcnt(5) lgkmcnt(12)
    v_mfma_f32_16x16x32_bf16 v[64:67], v[80:83], v[196:199], v[64:67]
    ds_read_b64_tr_b16 v[108:109], v17 offset:4096
    s_waitcnt vmcnt(4)
    v_mfma_f32_16x16x32_bf16 v[48:51], v[80:83], v[192:195], v[48:51]
    ds_read_b64_tr_b16 v[110:111], v17 offset:5120
    buffer_load_dwordx4 v[220:223], v11, s[28:31], s61 offen offset:2048 sc1
    s_waitcnt lgkmcnt(12)
    v_mfma_f32_16x16x32_bf16 v[68:71], v[84:87], v[196:199], v[68:71]
    ds_read_b64_tr_b16 v[80:81], v22 offset:0
    v_mfma_f32_16x16x32_bf16 v[52:55], v[84:87], v[192:195], v[52:55]
    ds_read_b64_tr_b16 v[82:83], v22 offset:1024
    s_waitcnt lgkmcnt(12)
    v_mfma_f32_16x16x32_bf16 v[72:75], v[88:91], v[196:199], v[72:75]
    ds_read_b64_tr_b16 v[84:85], v23 offset:0
    v_mfma_f32_16x16x32_bf16 v[56:59], v[88:91], v[192:195], v[56:59]
    ds_read_b64_tr_b16 v[86:87], v23 offset:1024
    buffer_load_dwordx4 v[216:219], v10, s[28:31], s61 offen offset:2048 sc1
    s_waitcnt lgkmcnt(12)
    v_mfma_f32_16x16x32_bf16 v[76:79], v[92:95], v[196:199], v[76:79]
    ds_read_b64_tr_b16 v[88:89], v24 offset:0
    v_mfma_f32_16x16x32_bf16 v[60:63], v[92:95], v[192:195], v[60:63]
    ds_read_b64_tr_b16 v[90:91], v24 offset:1024
    s_waitcnt vmcnt(5) lgkmcnt(12)
    v_mfma_f32_16x16x32_bf16 v[64:67], v[96:99], v[204:207], v[64:67]
    ds_read_b64_tr_b16 v[92:93], v25 offset:0
    s_waitcnt vmcnt(4)
    v_mfma_f32_16x16x32_bf16 v[48:51], v[96:99], v[200:203], v[48:51]
    ds_read_b64_tr_b16 v[94:95], v25 offset:1024
    s_and_b32 s46, s24, s25
    s_cbranch_scc1 L_s6_k
    s_call_b64 s[12:13], L_pl
L_s6_k:
    s_ff1_i32_b32 s27, s46
    s_bitset0_b32 s25, s27
    s_add_u32 s27, s27, s57
    s_and_b32 s27, s27, 7
    s_lshl_b32 s26, s27, 14
    s_add_u32 s42, s59, s26
    v_add_u32 v14, s26, v26
    v_xor_b32 v15, 32, v14
    v_xor_b32_e64 v16, 64, v14
    v_xor_b32 v17, 96, v14
    buffer_load_dwordx4 v[228:231], v11, s[28:31], s42 offen offset:0 sc1
    s_and_b32 s46, s24, s25
    s_cbranch_scc1 L_r6
    s_load_dwordx8 s[48:55], s[14:15], s58 glc
L_r6:
    s_waitcnt lgkmcnt(12)
    v_mfma_f32_16x16x32_bf16 v[68:71], v[100:103], v[204:207], v[68:71]
    ds_read_b64_tr_b16 v[96:97], v22 offset:4096
    v_mfma_f32_16x16x32_bf16 v[52:55], v[100:103], v[200:203], v[52:55]
    ds_read_b64_tr_b16 v[98:99], v22 offset:5120
    s_waitcnt lgkmcnt(12)
    v_mfma_f32_16x16x32_bf16 v[72:75], v[104:107], v[204:207], v[72:75]
    ds_read_b64_tr_b16 v[100:101], v23 offset:4096
    v_mfma_f32_16x16x32_bf16 v[56:59], v[104:107], v[200:203], v[56:59]
    ds_read_b64_tr_b16 v[102:103], v23 offset:5120
    buffer_load_dwordx4 v[224:227], v10, s[28:31], s42 offen offset:0 sc1
    s_waitcnt lgkmcnt(12)
    v_mfma_f32_16x16x32_bf16 v[76:79], v[108:111], v[204:207], v[76:79]
    ds_read_b64_tr_b16 v[104:105], v24 offset:4096
    v_mfma_f32_16x16x32_bf16 v[60:63], v[108:111], v[200:203], v[60:63]
    ds_read_b64_tr_b16 v[106:107], v24 offset:5120
    s_waitcnt vmcnt(5) lgkmcnt(12)
    v_mfma_f32_16x16x32_bf16 v[64:67], v[80:83], v[212:215], v[64:67]
    ds_read_b64_tr_b16 v[108:109], v25 offset:4096
    s_waitcnt vmcnt(4)
    v_mfma_f32_16x16x32_bf16 v[48:51], v[80:83], v[208:211], v[48:51]
    ds_read_b64_tr_b16 v[110:111], v25 offset:5120
    buffer_load_dwordx4 v[236:239], v11, s[28:31], s42 offen offset:2048 sc1
    s_waitcnt lgkmcnt(12)
    v_mfma_f32_16x16x32_bf16 v[68:71], v[84:87], v[212:215], v[68:71]
    ds_read_b64_tr_b16 v[80:81], v14 offset:0
    v_mfma_f32_16x16x32_bf16 v[52:55], v[84:87], v[208:211], v[52:55]
    ds_read_b64_tr_b16 v[82:83], v14 offset:1024
    s_waitcnt lgkmcnt(12)
    v_mfma_f32_16x16x32_bf16 v[72:75], v[88:91], v[212:215], v[72:75]
    ds_read_b64_tr_b16 v[84:85], v15 offset:0
    v_mfma_f32_16x16x32_bf16 v[56:59], v[88:91], v[208:211], v[56:59]
    ds_read_b64_tr_b16 v[86:87], v15 offset:1024
    buffer_load_dwordx4 v[232:235], v10, s[28:31], s42 offen offset:2048 sc1
    s_waitcnt lgkmcnt(12)
    v_mfma_f32_16x16x32_bf16 v[76:79], v[92:95], v[212:215], v[76:79]
    ds_read_b64_tr_b16 v[88:89], v16 offset:0
    v_mfma_f32_16x16x32_bf16 v[60:63], v[92:95], v[208:211], v[60:63]
    ds_read_b64_tr_b16 v[90:91], v16 offset:1024
    s_waitcnt vmcnt(5) lgkmcnt(12)
    v_mfma_f32_16x16x32_bf16 v[64:67], v[96:99], v[220:223], v[64:67]
    ds_read_b64_tr_b16 v[92:93], v17 offset:0
    s_waitcnt vmcnt(4)
    v_mfma_f32_16x16x32_bf16 v[48:51], v[96:99], v[216:219], v[48:51]
    ds_read_b64_tr_b16 v[94:95], v17 offset:1024
    s_and_b32 s46, s24, s25
    s_cbranch_scc1 L_s7_k
    s_call_b64 s[12:13], L_pl
L_s7_k:
    s_ff1_i32_b32 s27, s46
    s_bitset0_b32 s25, s27
    s_add_u32 s27, s27, s57
    s_and_b32 s27, s27, 7
    s_lshl_b32 s26, s27, 14
    s_add_u32 s60, s59, s26
    v_add_u32 v22, s26, v26
    v_xor_b32 v23, 32, v22
    v_xor_b32 v24, 64, v22
    v_xor_b32 v25, 96, v22
    buffer_load_dwordx4 v[244:247], v11, s[28:31], s60 offen offset:0 sc1
    s_waitcnt lgkmcnt(12)
    v_mfma_f32_16x16x32_bf16 v[68:71], v[100:103], v[220:223], v[68:71]
    ds_read_b64_tr_b16 v[96:97], v14 offset:4096
    v_mfma_f32_16x16x32_bf16 v[52:55], v[100:103], v[216:219], v[52:55]
    ds_read_b64_tr_b16 v[98:99], v14 offset:5120
    s_waitcnt lgkmcnt(12)
    v_mfma_f32_16x16x32_bf16 v[72:75], v[104:107], v[220:223], v[72:75]
    ds_read_b64_tr_b16 v[100:101], v15 offset:4096
    v_mfma_f32_16x16x32_bf16 v[56:59], v[104:107], v[216:219], v[56:59]
    ds_read_b64_tr_b16 v[102:103], v15 offset:5120
    buffer_load_dwordx4 v[240:243], v10, s[28:31], s60 offen offset:0 sc1
    s_waitcnt lgkmcnt(12)
    v_mfma_f32_16x16x32_bf16 v[76:79], v[108:111], v[220:223], v[76:79]
    ds_read_b64_tr_b16 v[104:105], v16 offset:4096
    v_mfma_f32_16x16x32_bf16 v[60:63], v[108:111], v[216:219], v[60:63]
    ds_read_b64_tr_b16 v[106:107], v16 offset:5120
    s_waitcnt vmcnt(5) lgkmcnt(12)
    v_mfma_f32_16x16x32_bf16 v[64:67], v[80:83], v[228:231], v[64:67]
    ds_read_b64_tr_b16 v[108:109], v17 offset:4096
    s_waitcnt vmcnt(4)
    v_mfma_f32_16x16x32_bf16 v[48:51], v[80:83], v[224:227], v[48:51]
    ds_read_b64_tr_b16 v[110:111], v17 offset:5120
    buffer_load_dwordx4 v[252:255], v11, s[28:31], s60 offen offset:2048 sc1
    s_waitcnt lgkmcnt(12)
    v_mfma_f32_16x16x32_bf16 v[68:71], v[84:87], v[228:231], v[68:71]
    ds_read_b64_tr_b16 v[80:81], v22 offset:0
    v_mfma_f32_16x16x32_bf16 v[52:55], v[84:87], v[224:227], v[52:55]
    ds_read_b64_tr_b16 v[82:83], v22 offset:1024
    s_waitcnt lgkmcnt(12)
    v_mfma_f32_16x16x32_bf16 v[72:75], v[88:91], v[228:231], v[72:75]
    ds_read_b64_tr_b16 v[84:85], v23 offset:0
    v_mfma_f32_16x16x32_bf16 v[56:59], v[88:91], v[224:227], v[56:59]
    ds_read_b64_tr_b16 v[86:87], v23 offset:1024
    buffer_load_dwordx4 v[248:251], v10, s[28:31], s60 offen offset:2048 sc1
    s_waitcnt lgkmcnt(12)
    v_mfma_f32_16x16x32_bf16 v[76:79], v[92:95], v[228:231], v[76:79]
    ds_read_b64_tr_b16 v[88:89], v24 offset:0
    v_mfma_f32_16x16x32_bf16 v[60:63], v[92:95], v[224:227], v[60:63]
    ds_read_b64_tr_b16 v[90:91], v24 offset:1024
    s_waitcnt vmcnt(5) lgkmcnt(12)
    v_mfma_f32_16x16x32_bf16 v[64:67], v[96:99], v[236:239], v[64:67]
    ds_read_b64_tr_b16 v[92:93], v25 offset:0
    s_waitcnt vmcnt(4)
    v_mfma_f32_16x16x32_bf16 v[48:51], v[96:99], v[232:235], v[48:51]
    ds_read_b64_tr_b16 v[94:95], v25 offset:1024
    s_waitcnt lgkmcnt(12)
    v_mfma_f32_16x16x32_bf16 v[68:71], v[100:103], v[236:239], v[68:71]
    ds_read_b64_tr_b16 v[96:97], v22 offset:4096
    v_mfma_f32_16x16x32_bf16 v[52:55], v[100:103], v[232:235], v[52:55]
    ds_read_b64_tr_b16 v[98:99], v22 offset:5120
    s_waitcnt lgkmcnt(12)
    v_mfma_f32_16x16x32_bf16 v[72:75], v[104:107], v[236:239], v[72:75]
    ds_read_b64_tr_b16 v[100:101], v23 offset:4096
    v_mfma_f32_16x16x32_bf16 v[56:59], v[104:107], v[232:235], v[56:59]
    ds_read_b64_tr_b16 v[102:103], v23 offset:5120
    s_waitcnt lgkmcnt(12)
    v_mfma_f32_16x16x32_bf16 v[76:79], v[108:111], v[236:239], v[76:79]
    ds_read_b64_tr_b16 v[104:105], v24 offset:4096
    v_mfma_f32_16x16x32_bf16 v[60:63], v[108:111], v[232:235], v[60:63]
    ds_read_b64_tr_b16 v[106:107], v24 offset:5120
    s_waitcnt vmcnt(3) lgkmcnt(12)
    v_mfma_f32_16x16x32_bf16 v[64:67], v[80:83], v[244:247], v[64:67]
    ds_read_b64_tr_b16 v[108:109], v25 offset:4096
    s_waitcnt vmcnt(2)
    v_mfma_f32_16x16x32_bf16 v[48:51], v[80:83], v[240:243], v[48:51]
    ds_read_b64_tr_b16 v[110:111], v25 offset:5120
    s_waitcnt lgkmcnt(12)
    v_mfma_f32_16x16x32_bf16 v[68:71], v[84:87], v[244:247], v[68:71]
    v_mfma_f32_16x16x32_bf16 v[52:55], v[84:87], v[240:243], v[52:55]
    s_waitcnt lgkmcnt(10)
    v_mfma_f32_16x16x32_bf16 v[72:75], v[88:91], v[244:247], v[72:75]
    v_mfma_f32_16x16x32_bf16 v[56:59], v[88:91], v[240:243], v[56:59]
    s_waitcnt lgkmcnt(8)
    v_mfma_f32_16x16x32_bf16 v[76:79], v[92:95], v[244:247], v[76:79]
    v_mfma_f32_16x16x32_bf16 v[60:63], v[92:95], v[240:243], v[60:63]
    s_waitcnt lgkmcnt(0)
    s_cmp_lg_u32 s47, 0
    s_cbranch_scc1 L_as
    s_barrier
    ds_read_b128 v[144:147], v18 offset:0
    ds_read_b128 v[148:151], v18 offset:1024
    ds_read_b128 v[152:155], v18 offset:2048
    ds_read_b128 v[156:159], v18 offset:3072
    ds_read_b128 v[128:131], v18 offset:4096
    ds_read_b128 v[132:135], v18 offset:5120
    ds_read_b128 v[136:139], v18 offset:6144
    ds_read_b128 v[140:143], v18 offset:7168
    s_waitcnt vmcnt(1)
    v_mfma_f32_16x16x32_bf16 v[64:67], v[96:99], v[252:255], v[64:67]
    v_mfma_f32_16x16x32_bf16 v[68:71], v[100:103], v[252:255], v[68:71]
    v_mfma_f32_16x16x32_bf16 v[72:75], v[104:107], v[252:255], v[72:75]
    v_mfma_f32_16x16x32_bf16 v[76:79], v[108:111], v[252:255], v[76:79]
    s_waitcnt vmcnt(0)
    v_mfma_f32_16x16x32_bf16 v[48:51], v[96:99], v[248:251], v[48:51]
    v_mfma_f32_16x16x32_bf16 v[52:55], v[100:103], v[248:251], v[52:55]
    v_mfma_f32_16x16x32_bf16 v[56:59], v[104:107], v[248:251], v[56:59]
    v_mfma_f32_16x16x32_bf16 v[60:63], v[108:111], v[248:251], v[60:63]
    s_add_u32 s42, s41, 32768
    s_nop 0
    s_waitcnt lgkmcnt(0)
    v_pk_add_f32 v[64:65], v[64:65], v[144:145]
    v_pk_add_f32 v[66:67], v[66:67], v[146:147]
    v_pk_add_f32 v[68:69], v[68:69], v[148:149]
    v_pk_add_f32 v[70:71], v[70:71], v[150:151]
    v_cvt_pk_bf16_f32 v120, v64, v65
    v_cvt_pk_bf16_f32 v121, v66, v67
    v_cvt_pk_bf16_f32 v122, v68, v69
    v_cvt_pk_bf16_f32 v123, v70, v71
    s_nop 0
    v_permlane16_swap_b32 v120, v122
    v_permlane16_swap_b32 v121, v123
    ds_write_b128 v27, v[120:123] offset:2048
    s_nop 0
    v_pk_add_f32 v[72:73], v[72:73], v[152:153]
    v_pk_add_f32 v[74:75], v[74:75], v[154:155]
    v_pk_add_f32 v[76:77], v[76:77], v[156:157]
    v_pk_add_f32 v[78:79], v[78:79], v[158:159]
    v_cvt_pk_bf16_f32 v124, v72, v73
    v_cvt_pk_bf16_f32 v125, v74, v75
    v_cvt_pk_bf16_f32 v126, v76, v77
    v_cvt_pk_bf16_f32 v127, v78, v79
    s_nop 0
    v_permlane16_swap_b32 v124, v126
    v_permlane16_swap_b32 v125, v127
    ds_write_b128 v28, v[124:127] offset:2048
    ds_read_b128 v[88:91], v29 offset:2048
    ds_read_b128 v[92:95], v29 offset:3072
    s_nop 0
    v_pk_add_f32 v[48:49], v[48:49], v[128:129]
    v_pk_add_f32 v[50:51], v[50:51], v[130:131]
    v_pk_add_f32 v[52:53], v[52:53], v[132:133]
    v_pk_add_f32 v[54:55], v[54:55], v[134:135]
    v_cvt_pk_bf16_f32 v112, v48, v49
    v_cvt_pk_bf16_f32 v113, v50, v51
    v_cvt_pk_bf16_f32 v114, v52, v53
    v_cvt_pk_bf16_f32 v115, v54, v55
    s_nop 0
    v_permlane16_swap_b32 v112, v114
    v_permlane16_swap_b32 v113, v115
    ds_write_b128 v27, v[112:115] offset:0
    s_waitcnt lgkmcnt(2)
    buffer_store_dwordx4 v[88:91], v20, s[36:39], s42 offen sc1
    s_waitcnt lgkmcnt(1)
    buffer_store_dwordx4 v[92:95], v21, s[36:39], s42 offen sc1
    s_nop 0
    v_pk_add_f32 v[56:57], v[56:57], v[136:137]
    v_pk_add_f32 v[58:59], v[58:59], v[138:139]
    v_pk_add_f32 v[60:61], v[60:61], v[140:141]
    v_pk_add_f32 v[62:63], v[62:63], v[142:143]
    v_cvt_pk_bf16_f32 v116, v56, v57
    v_cvt_pk_bf16_f32 v117, v58, v59
    v_cvt_pk_bf16_f32 v118, v60, v61
    v_cvt_pk_bf16_f32 v119, v62, v63
    s_nop 0
    v_permlane16_swap_b32 v116, v118
    v_permlane16_swap_b32 v117, v119
    ds_write_b128 v28, v[116:119] offset:0
    ds_read_b128 v[80:83], v29 offset:0
    ds_read_b128 v[84:87], v29 offset:1024
    s_waitcnt lgkmcnt(1)
    buffer_store_dwordx4 v[80:83], v20, s[36:39], s41 offen sc1
    s_waitcnt lgkmcnt(0)
    buffer_store_dwordx4 v[84:87], v21, s[36:39], s41 offen sc1
    s_branch L_fin
L_as:
L_pad10:
    s_cbranch_execz L_ret
    s_nop 0
    s_waitcnt vmcnt(1)
    v_mfma_f32_16x16x32_bf16 v[64:67], v[96:99], v[252:255], v[64:67]
    v_mfma_f32_16x16x32_bf16 v[68:71], v[100:103], v[252:255], v[68:71]
    v_mfma_f32_16x16x32_bf16 v[72:75], v[104:107], v[252:255], v[72:75]
    s_nop 5
    ds_write_b128 v19, v[64:67] offset:4096
    v_mfma_f32_16x16x32_bf16 v[76:79], v[108:111], v[252:255], v[76:79]
    ds_write_b128 v19, v[68:71] offset:5120
    s_waitcnt vmcnt(0)
    v_mfma_f32_16x16x32_bf16 v[48:51], v[96:99], v[248:251], v[48:51]
    ds_write_b128 v19, v[72:75] offset:6144
    v_mfma_f32_16x16x32_bf16 v[52:55], v[100:103], v[248:251], v[52:55]
    s_nop 2
    ds_write_b128 v19, v[76:79] offset:7168
    v_mfma_f32_16x16x32_bf16 v[56:59], v[104:107], v[248:251], v[56:59]
    s_nop 0
    ds_write_b128 v19, v[48:51] offset:0
    v_mfma_f32_16x16x32_bf16 v[60:63], v[108:111], v[248:251], v[60:63]
    ds_write_b128 v19, v[52:55] offset:1024
    s_nop 3
    ds_write_b128 v19, v[56:59] offset:2048
    s_nop 1
    ds_write_b128 v19, v[60:63] offset:3072
    s_waitcnt lgkmcnt(0)
    s_barrier
    s_branch L_noep
L_fin:
    s_or_b32 s46, s2, s3
    s_or_b32 s46, s46, s47
    s_cmp_lg_u32 s46, 0
    s_cbranch_scc1 L_noep
    v_mov_b32 v1, s44
    v_mov_b32 v2, 0
    s_mov_b64 exec, 1
    buffer_store_dword v1, v2, s[28:31], 0 offen sc1
    s_mov_b64 exec, -1
L_noep:
L_end:
    s_endpgm
.p2align 12
L_A:
    s_sub_u32 s3, s3, 4
    s_and_b32 s46, s2, 7
    s_lshr_b32 s47, s54, 1
    s_lshl_b32 s46, s46, 2
    s_lshl_b32 s47, s47, 1
    s_add_u32 s46, s46, s47
    s_lshr_b32 s47, 0x110011, s46
    s_and_b32 s47, s47, 3
    s_cmp_eq_u32 s47, 3
    s_cselect_b32 s59, 6, 0
    s_cselect_b32 s58, 0, 1
    s_cselect_b32 s47, 1, s47
    s_cmp_ge_u32 s3, s47
    s_cselect_b32 s61, 1, 0
    s_bitcmp1_b32 s2, 2
    s_mov_b32 s47, 0x00000303
    s_cselect_b32 s47, 0x00000b0b, s47
    s_lshl_b32 s46, s46, 1
    s_lshr_b32 s47, s47, s46
    s_and_b32 s52, s47, 15
    s_add_u32 s46, s51, s3
    s_and_b32 s46, s46, s58
    s_lshl_b32 s46, s46, 9
    s_and_b32 s47, s54, 1
    s_lshl_b32 s47, s47, 5
    s_add_u32 s46, s46, s47
    s_lshl_b32 s47, s53, 2
    s_add_u32 s46, s46, s47
    v_lshrrev_b32 v1, 3, v0
    v_and_b32 v2, s59, v1
    v_add_u32 v1, v1, v2
    v_bfe_u32 v2, v0, 1, 2
    v_lshl_add_u32 v1, v1, 6, v2
    v_add_u32_e64 v1, s46, v1
    v_mul_u32_u24 v1, 6144, v1
    v_and_b32_e64 v2, 1, v0
    v_lshl_add_u32 v47, v2, 11, v1
    s_lshl_b32 s60, s52, 7
    s_add_u32 s60, s60, 2048
    s_waitcnt lgkmcnt(0)
    s_mov_b32 s4, s6
    s_mov_b32 s5, s7
    s_mov_b32 s6, 6291456
    s_mov_b32 s7, 0x20000
    s_cmp_lg_u32 s61, 0
    s_cbranch_scc1 L_h0
    buffer_load_dword v47, v47, s[4:7], s60 offen
L_h0:
    s_xor_b32 s46, s3, 1
    s_or_b32 s61, s61, s46
    s_lshl_b32 s55, s3, 12
    s_lshl_b32 s56, s3, 11
    s_and_b32 s52, s3, 1
    s_lshr_b32 s51, s3, 1
    v_lshrrev_b32_e64 v1, 4, v0
    v_bfe_u32 v2, v0, 1, 3
    v_xor_b32 v1, v1, v2
    v_lshlrev_b32 v1, 4, v1
    v_and_b32_e64 v2, 15, v0
    v_lshl_add_u32 v10, v2, 7, v1
    v_xor_b32 v11, 64, v10
    s_xor_b32 s46, s55, 4096
    v_add_u32 v12, s46, v10
    v_add_u32 v13, s46, v11
    v_add_u32 v10, s55, v10
    v_add_u32 v11, s55, v11
    v_lshrrev_b32 v1, 4, v0
    v_bfe_u32 v2, v0, 2, 2
    v_lshl_add_u32 v1, v1, 3, v2
    v_lshlrev_b32 v1, 7, v1
    v_and_b32 v2, 3, v0
    v_lshl_add_u32 v1, v2, 3, v1
    v_bfe_u32 v2, v0, 3, 2
    v_lshl_add_u32 v16, v2, 5, v1
    s_lshl_b32 s46, s52, 6
    v_xor_b32 v14, s46, v16
    v_add_u32 v14, 49152, v14
    v_xor_b32 v15, 32, v14
    v_lshrrev_b32 v1, 5, v0
    v_bfe_u32 v2, v0, 2, 2
    v_lshl_add_u32 v1, v1, 3, v2
    v_lshlrev_b32_e64 v1, 6, v1
    v_bfe_u32 v2, v0, 4, 1
    v_lshl_add_u32 v1, v2, 5, v1
    v_and_b32_e64 v2, 3, v0
    v_lshl_add_u32 v17, v2, 3, v1
    s_and_b32 s46, s49, 1
    s_lshl_b32 s46, s46, 12
    s_lshl_b32 s47, s52, 11
    s_add_u32 s46, s46, s47
    s_add_u32 s46, s46, 155648
    v_add_u32 v17, s46, v17
    v_lshlrev_b32 v9, 4, v0
    v_lshlrev_b32 v8, 2, v0
    v_and_b32 v1, 15, v0
    v_lshlrev_b32 v1, 6, v1
    v_lshrrev_b32 v2, 5, v0
    v_bfe_u32 v3, v0, 2, 2
    v_xor_b32_e64 v2, v2, v3
    v_lshl_add_u32 v1, v2, 4, v1
    v_lshrrev_b32 v2, 3, v0
    v_xor_b32 v2, v2, v0
    v_bfe_u32 v2, v2, 1, 1
    v_lshl_add_u32 v1, v2, 3, v1
    s_lshl_b32 s54, s52, 13
    s_add_u32 s54, s54, 49152
    s_add_u32 s46, s54, s56
    v_add_u32 v20, s46, v1
    v_xor_b32 v21, 32, v20
    v_xor_b32 v22, 2048, v20
    v_xor_b32 v23, 2048, v21
    s_mul_i32 s53, s52, 49152
    s_add_u32 s53, s53, 16384
    s_add_u32 s46, s53, s56
    v_and_b32 v1, 31, v0
    v_lshlrev_b32 v1, 6, v1
    v_lshrrev_b32 v2, 5, v0
    v_lshl_add_u32 v1, v2, 3, v1
    v_bfe_u32 v2, v0, 2, 2
    v_lshl_add_u32 v1, v2, 4, v1
    v_add_u32 v4, s46, v1
    v_xor_b32 v5, 16, v4
    v_xor_b32 v6, 32, v4
    v_xor_b32 v7, 48, v4
    v_and_b32 v1, 2, v0
    v_lshlrev_b32 v1, 2, v1
    v_xor_b32 v4, v1, v4
    v_xor_b32 v5, v1, v5
    v_xor_b32 v6, v1, v6
    v_xor_b32 v7, v1, v7
    v_xor_b32 v40, 2048, v4
    v_xor_b32 v41, 2048, v5
    v_xor_b32 v42, 2048, v6
    v_xor_b32 v43, 2048, v7
    v_lshrrev_b32_e64 v1, 5, v0
    v_bfe_u32 v2, v0, 2, 2
    v_lshl_add_u32 v2, v1, 3, v2
    v_lshlrev_b32_e64 v2, 6, v2
    v_bfe_u32 v3, v0, 4, 1
    v_xor_b32_e64 v3, v3, v1
    v_lshl_add_u32 v2, v3, 5, v2
    v_and_b32_e64 v3, 3, v0
    v_lshl_add_u32 v2, v3, 3, v2
    v_and_b32 v3, 8, v0
    v_xor_b32 v2, v2, v3
    v_xor_b32_e64 v3, 16, v2
    v_add_u32 v3, 256, v3
    s_lshl_b32 s46, s51, 13
    s_add_u32 s46, s46, s53
    v_add_u32 v32, s46, v2
    v_add_u32 v33, s46, v3
    v_add_u32 v34, s54, v2
    v_add_u32 v35, s54, v3
    v_lshrrev_b32 v1, 2, v0
    v_lshrrev_b32 v2, 4, v0
    v_xor_b32 v1, v1, v2
    v_and_b32 v1, 1, v1
    v_subrev_u32_e64 v1, 1, v1
    v_and_b32 v36, 0x3f803f80, v1
    v_mov_b32 v37, v36
    v_mov_b32 v38, v36
    v_mov_b32 v39, v36
    v_and_b32 v1, 15, v0
    v_lshlrev_b32_e64 v1, 4, v1
    v_lshl_add_u32 v44, v2, 15, v1
    v_and_b32_e64 v2, 1, v2
    v_lshl_add_u32 v46, v2, 12, v1
    v_lshrrev_b32_e64 v2, 5, v0
    v_lshl_add_u32 v46, v2, 14, v46
    v_lshrrev_b32 v1, 4, v0
    v_lshlrev_b32 v1, 1, v1
    v_and_b32 v2, 7, v0
    v_xor_b32 v1, v1, v2
    v_lshlrev_b32 v1, 4, v1
    v_lshrrev_b32 v2, 3, v0
    v_lshl_add_u32 v1, v2, 11, v1
    s_lshl_b32 s46, s3, 15
    v_add_u32 v18, s46, v1
    v_add_u32 v19, 15360, v18
    s_mul_i32 s46, s51, 49152
    s_lshl_b32 s47, s52, 13
    s_add_u32 s46, s46, s47
    s_add_u32 s46, s46, 16384
    v_add_u32 v45, s46, v9
    s_lshl_b32 s46, s52, 1
    s_add_u32 s46, s46, s51
    s_lshl_b32 s47, s49, 2
    s_add_u32 s46, s46, s47
    s_lshl_b32 s57, s46, 16
    s_lshl_b32 s47, s48, 10
    s_add_u32 s57, s57, s47
    s_and_b32 s47, s57, 0x1fff
    s_lshl_b32 s57, s57, 1
    s_sub_u32 s57, s57, s47
    s_lshr_b32 s47, s57, 8
    s_and_b32 s47, s47, 0x2000
    s_xor_b32 s57, s57, s47
    s_add_u32 s57, s57, 8388608
    s_lshl_b32 s58, s46, 9
    s_lshl_b32 s47, s48, 2
    s_add_u32 s58, s58, s47
    s_and_b32 s47, s58, 0x1fff
    s_lshl_b32 s58, s58, 1
    s_sub_u32 s58, s58, s47
    s_add_u32 s58, s58, 524288
    s_lshl_b32 s47, s49, 4
    s_add_u32 s47, s47, s48
    s_lshl_b32 s16, s47, 7
    s_lshr_b32 s17, s47, 2
    s_lshl_b32 s17, s17, 9
    s_and_b32 s46, s48, 3
    s_lshl_b32 s47, s46, 4
    s_add_u32 s17, s17, s47
    s_lshl_b32 s47, s3, 2
    s_add_u32 s17, s17, s47
    s_xor_b32 s20, s49, 1
    s_lshl_b32 s20, s20, 4
    s_add_u32 s20, s20, s47
    s_add_u32 s20, s20, s46
    s_lshl_b32 s20, s20, 7
    s_and_b32 s47, s16, 0x1fff
    s_lshl_b32 s16, s16, 1
    s_sub_u32 s16, s16, s47
    s_add_u32 s16, s16, 524288
    s_and_b32 s47, s17, 0x1fff
    s_lshl_b32 s17, s17, 1
    s_sub_u32 s17, s17, s47
    s_add_u32 s17, s17, 589824
    s_and_b32 s47, s20, 0x1fff
    s_lshl_b32 s20, s20, 1
    s_sub_u32 s20, s20, s47
    s_add_u32 s20, s20, 589824
    s_lshl_b32 s47, s49, 4
    s_add_u32 s47, s47, s48
    s_lshl_b32 s46, s3, 8
    s_lshl_b32 s18, s47, 15
    s_add_u32 s18, s18, s46
    s_lshl_b32 s22, s47, 10
    s_add_u32 s22, s22, s46
    s_xor_b32 s24, s49, 1
    s_lshl_b32 s24, s24, 14
    s_add_u32 s24, s24, s55
    s_lshl_b32 s21, s3, 6
    s_add_u32 s21, s21, 8192
    s_lshr_b32 s47, s18, 8
    s_and_b32 s47, s47, 0x2000
    s_xor_b32 s18, s18, s47
    s_add_u32 s18, s18, 8388608
    s_and_b32 s47, s22, 0x1fff
    s_lshl_b32 s22, s22, 1
    s_sub_u32 s22, s22, s47
    s_add_u32 s22, s22, 1048576
    s_and_b32 s47, s24, 0x1fff
    s_lshl_b32 s24, s24, 1
    s_sub_u32 s24, s24, s47
    s_add_u32 s24, s24, 1048576
    s_waitcnt lgkmcnt(0)
    s_load_dword s44, s[14:15], 0
    s_mov_b32 s31, 0x20000
    s_mov_b32 s35, 0x20000
    s_mov_b32 s39, 0x20000
    s_mov_b32 s28, s14
    s_mov_b32 s29, s15
    s_mov_b32 s30, 0x10000000
    s_bfe_u32 s46, s2, 0x30003
    s_and_b32 s47, s2, 1
    s_lshl_b32 s47, s47, 3
    s_add_u32 s46, s46, s47
    s_lshl_b32 s46, s46, 7
    s_add_u32 s32, s10, s46
    s_addc_u32 s33, s11, 0
    s_sub_u32 s34, 2097152, s46
    s_mov_b32 s36, s12
    s_mov_b32 s37, s13
    s_mov_b32 s38, 4194304
    s_mov_b32 s40, 0x3fb8aa3b
    s_mov_b32 s41, 0x3fb8aa3b
    s_mov_b32 s42, 0xbfb8aa3b
    s_mov_b32 s43, 0xbfb8aa3b
    s_lshl_b32 s46, s2, 10
    s_lshl_b32 s47, s3, 8
    s_add_u32 s46, s46, s47
    s_add_u32 s46, s46, 524288
    v_mov_b32 v1, 0
    v_lshlrev_b32 v2, 7, v0
    s_mov_b64 exec, 3
    buffer_atomic_or v1, v2, s[28:31], s46 offen
    s_mov_b64 exec, -1
    s_waitcnt lgkmcnt(0)
    s_add_u32 s44, s44, 0x9e3779b9
    s_and_b32 s44, s44, 0xbfffbfff
    s_barrier
    ds_read_b128 v[240:243], v10 offset:32768
    ds_read_b64_tr_b16 v[128:129], v14 offset:32768
    ds_read_b64_tr_b16 v[130:131], v14 offset:33280
    ds_read_b128 v[244:247], v10 offset:34816
    ds_read_b128 v[112:115], v12 offset:32768
    ds_read_b128 v[116:119], v12 offset:34816
    ds_read_b64_tr_b16 v[132:133], v15 offset:32768
    ds_read_b64_tr_b16 v[134:135], v15 offset:33280
    ds_read_b64_tr_b16 v[136:137], v14 offset:40960
    ds_read_b64_tr_b16 v[138:139], v14 offset:41472
    ds_read_b64_tr_b16 v[140:141], v15 offset:40960
    ds_read_b64_tr_b16 v[142:143], v15 offset:41472
    s_waitcnt lgkmcnt(9)
    v_mfma_f32_16x16x32_bf16 v[48:51], v[128:131], v[240:243], 0
    ds_read_b128 v[248:251], v11 offset:32768
    s_waitcnt lgkmcnt(9)
    v_mfma_f32_16x16x32_bf16 v[56:59], v[128:131], v[244:247], 0
    ds_read_b64_tr_b16 v[144:145], v14 offset:36864
    s_waitcnt lgkmcnt(9)
    v_mfma_f32_16x16x32_bf16 v[64:67], v[128:131], v[112:115], 0
    ds_read_b64_tr_b16 v[146:147], v14 offset:37376
    s_waitcnt lgkmcnt(9)
    v_mfma_f32_16x16x32_bf16 v[72:75], v[128:131], v[116:119], 0
    ds_read_b128 v[252:255], v11 offset:34816
    s_waitcnt lgkmcnt(8)
    v_mfma_f32_16x16x32_bf16 v[52:55], v[132:135], v[240:243], 0
    ds_read_b128 v[120:123], v13 offset:32768
    v_mfma_f32_16x16x32_bf16 v[60:63], v[132:135], v[244:247], 0
    ds_read_b128 v[124:127], v13 offset:34816
    v_mfma_f32_16x16x32_bf16 v[68:71], v[132:135], v[112:115], 0
    ds_read_b64_tr_b16 v[148:149], v15 offset:36864
    v_mfma_f32_16x16x32_bf16 v[76:79], v[132:135], v[116:119], 0
    ds_read_b64_tr_b16 v[150:151], v15 offset:37376
    s_waitcnt lgkmcnt(10)
    v_mfma_f32_16x16x32_bf16 v[80:83], v[136:139], v[240:243], 0
    ds_read_b64_tr_b16 v[152:153], v14 offset:45056
    v_mfma_f32_16x16x32_bf16 v[88:91], v[136:139], v[244:247], 0
    ds_read_b64_tr_b16 v[154:155], v14 offset:45568
    v_mfma_f32_16x16x32_bf16 v[96:99], v[136:139], v[112:115], 0
    ds_read_b64_tr_b16 v[156:157], v15 offset:45056
    v_mfma_f32_16x16x32_bf16 v[104:107], v[136:139], v[116:119], 0
    ds_read_b64_tr_b16 v[158:159], v15 offset:45568
    s_waitcnt lgkmcnt(12)
    v_mfma_f32_16x16x32_bf16 v[84:87], v[140:143], v[240:243], 0
    v_mfma_f32_16x16x32_bf16 v[92:95], v[140:143], v[244:247], 0
    v_mfma_f32_16x16x32_bf16 v[100:103], v[140:143], v[112:115], 0
    v_mfma_f32_16x16x32_bf16 v[108:111], v[140:143], v[116:119], 0
    s_waitcnt lgkmcnt(9)
    v_mfma_f32_16x16x32_bf16 v[48:51], v[144:147], v[248:251], v[48:51]
    s_waitcnt lgkmcnt(8)
    v_mfma_f32_16x16x32_bf16 v[56:59], v[144:147], v[252:255], v[56:59]
    s_waitcnt lgkmcnt(7)
    v_mfma_f32_16x16x32_bf16 v[64:67], v[144:147], v[120:123], v[64:67]
    s_waitcnt lgkmcnt(6)
    v_mfma_f32_16x16x32_bf16 v[72:75], v[144:147], v[124:127], v[72:75]
    s_waitcnt lgkmcnt(0)
    s_barrier
    v_mfma_f32_16x16x32_bf16 v[52:55], v[148:151], v[248:251], v[52:55]
    ds_read_b128 v[240:243], v10 offset:0
    v_mfma_f32_16x16x32_bf16 v[60:63], v[148:151], v[252:255], v[60:63]
    ds_read_b64_tr_b16 v[128:129], v14 offset:0
    v_mfma_f32_16x16x32_bf16 v[68:71], v[148:151], v[120:123], v[68:71]
    ds_read_b64_tr_b16 v[130:131], v14 offset:512
    v_mfma_f32_16x16x32_bf16 v[76:79], v[148:151], v[124:127], v[76:79]
    ds_read_b128 v[244:247], v10 offset:2048
    v_mfma_f32_16x16x32_bf16 v[80:83], v[152:155], v[248:251], v[80:83]
    ds_read_b128 v[112:115], v12 offset:0
    v_mfma_f32_16x16x32_bf16 v[88:91], v[152:155], v[252:255], v[88:91]
    ds_read_b128 v[116:119], v12 offset:2048
    v_mfma_f32_16x16x32_bf16 v[96:99], v[152:155], v[120:123], v[96:99]
    ds_read_b64_tr_b16 v[132:133], v15 offset:0
    v_mfma_f32_16x16x32_bf16 v[104:107], v[152:155], v[124:127], v[104:107]
    ds_read_b64_tr_b16 v[134:135], v15 offset:512
    v_mfma_f32_16x16x32_bf16 v[84:87], v[156:159], v[248:251], v[84:87]
    ds_read_b64_tr_b16 v[136:137], v14 offset:8192
    v_mfma_f32_16x16x32_bf16 v[92:95], v[156:159], v[252:255], v[92:95]
    ds_read_b64_tr_b16 v[138:139], v14 offset:8704
    v_mfma_f32_16x16x32_bf16 v[100:103], v[156:159], v[120:123], v[100:103]
    ds_read_b64_tr_b16 v[140:141], v15 offset:8192
    v_mfma_f32_16x16x32_bf16 v[108:111], v[156:159], v[124:127], v[108:111]
    ds_read_b64_tr_b16 v[142:143], v15 offset:8704
    s_waitcnt lgkmcnt(9)
    v_mfma_f32_16x16x32_bf16 v[48:51], v[128:131], v[240:243], v[48:51]
    ds_read_b128 v[248:251], v11 offset:0
    s_waitcnt lgkmcnt(9)
    v_mfma_f32_16x16x32_bf16 v[56:59], v[128:131], v[244:247], v[56:59]
    ds_read_b64_tr_b16 v[144:145], v14 offset:4096
    s_waitcnt lgkmcnt(9)
    v_mfma_f32_16x16x32_bf16 v[64:67], v[128:131], v[112:115], v[64:67]
    ds_read_b64_tr_b16 v[146:147], v14 offset:4608
    s_waitcnt lgkmcnt(9)
    v_mfma_f32_16x16x32_bf16 v[72:75], v[128:131], v[116:119], v[72:75]
    ds_read_b128 v[252:255], v11 offset:2048
    s_waitcnt lgkmcnt(8)
    v_mfma_f32_16x16x32_bf16 v[52:55], v[132:135], v[240:243], v[52:55]
    ds_read_b128 v[120:123], v13 offset:0
    v_mfma_f32_16x16x32_bf16 v[60:63], v[132:135], v[244:247], v[60:63]
    ds_read_b128 v[124:127], v13 offset:2048
    v_mfma_f32_16x16x32_bf16 v[68:71], v[132:135], v[112:115], v[68:71]
    ds_read_b64_tr_b16 v[148:149], v15 offset:4096
    v_mfma_f32_16x16x32_bf16 v[76:79], v[132:135], v[116:119], v[76:79]
    ds_read_b64_tr_b16 v[150:151], v15 offset:4608
    s_waitcnt lgkmcnt(10)
    v_mfma_f32_16x16x32_bf16 v[80:83], v[136:139], v[240:243], v[80:83]
    ds_read_b64_tr_b16 v[152:153], v14 offset:12288
    v_mfma_f32_16x16x32_bf16 v[88:91], v[136:139], v[244:247], v[88:91]
    ds_read_b64_tr_b16 v[154:155], v14 offset:12800
    v_mfma_f32_16x16x32_bf16 v[96:99], v[136:139], v[112:115], v[96:99]
    ds_read_b64_tr_b16 v[156:157], v15 offset:12288
    v_mfma_f32_16x16x32_bf16 v[104:107], v[136:139], v[116:119], v[104:107]
    ds_read_b64_tr_b16 v[158:159], v15 offset:12800
    s_waitcnt lgkmcnt(12)
    v_mfma_f32_16x16x32_bf16 v[84:87], v[140:143], v[240:243], v[84:87]
    v_mfma_f32_16x16x32_bf16 v[92:95], v[140:143], v[244:247], v[92:95]
    v_mfma_f32_16x16x32_bf16 v[100:103], v[140:143], v[112:115], v[100:103]
    v_mfma_f32_16x16x32_bf16 v[108:111], v[140:143], v[116:119], v[108:111]
    s_waitcnt lgkmcnt(9)
    v_mfma_f32_16x16x32_bf16 v[48:51], v[144:147], v[248:251], v[48:51]
    s_waitcnt lgkmcnt(8)
    v_mfma_f32_16x16x32_bf16 v[56:59], v[144:147], v[252:255], v[56:59]
    s_waitcnt lgkmcnt(7)
    v_mfma_f32_16x16x32_bf16 v[64:67], v[144:147], v[120:123], v[64:67]
    s_waitcnt lgkmcnt(6)
    v_mfma_f32_16x16x32_bf16 v[72:75], v[144:147], v[124:127], v[72:75]
    s_waitcnt lgkmcnt(0)
    s_barrier
    v_mfma_f32_16x16x32_bf16 v[52:55], v[148:151], v[248:251], v[52:55]
    ds_read_b128 v[240:243], v10 offset:16384
    v_mfma_f32_16x16x32_bf16 v[60:63], v[148:151], v[252:255], v[60:63]
    ds_read_b64_tr_b16 v[128:129], v14 offset:16384
    v_mfma_f32_16x16x32_bf16 v[68:71], v[148:151], v[120:123], v[68:71]
    ds_read_b64_tr_b16 v[130:131], v14 offset:16896
    v_mfma_f32_16x16x32_bf16 v[76:79], v[148:151], v[124:127], v[76:79]
    ds_read_b128 v[244:247], v10 offset:18432
    v_mfma_f32_16x16x32_bf16 v[80:83], v[152:155], v[248:251], v[80:83]
    ds_read_b128 v[112:115], v12 offset:16384
    v_mfma_f32_16x16x32_bf16 v[88:91], v[152:155], v[252:255], v[88:91]
    ds_read_b128 v[116:119], v12 offset:18432
    v_mfma_f32_16x16x32_bf16 v[96:99], v[152:155], v[120:123], v[96:99]
    ds_read_b64_tr_b16 v[132:133], v15 offset:16384
    v_mfma_f32_16x16x32_bf16 v[104:107], v[152:155], v[124:127], v[104:107]
    ds_read_b64_tr_b16 v[134:135], v15 offset:16896
    v_mfma_f32_16x16x32_bf16 v[84:87], v[156:159], v[248:251], v[84:87]
    ds_read_b64_tr_b16 v[136:137], v14 offset:24576
    v_mfma_f32_16x16x32_bf16 v[92:95], v[156:159], v[252:255], v[92:95]
    ds_read_b64_tr_b16 v[138:139], v14 offset:25088
    v_mfma_f32_16x16x32_bf16 v[100:103], v[156:159], v[120:123], v[100:103]
    ds_read_b64_tr_b16 v[140:141], v15 offset:24576
    v_mfma_f32_16x16x32_bf16 v[108:111], v[156:159], v[124:127], v[108:111]
    ds_read_b64_tr_b16 v[142:143], v15 offset:25088
    s_waitcnt lgkmcnt(9)
    v_mfma_f32_16x16x32_bf16 v[48:51], v[128:131], v[240:243], v[48:51]
    ds_read_b128 v[248:251], v11 offset:16384
    s_waitcnt lgkmcnt(9)
    v_mfma_f32_16x16x32_bf16 v[56:59], v[128:131], v[244:247], v[56:59]
    ds_read_b64_tr_b16 v[144:145], v14 offset:20480
    s_waitcnt lgkmcnt(9)
    v_mfma_f32_16x16x32_bf16 v[64:67], v[128:131], v[112:115], v[64:67]
    ds_read_b64_tr_b16 v[146:147], v14 offset:20992
    s_waitcnt lgkmcnt(9)
    v_mfma_f32_16x16x32_bf16 v[72:75], v[128:131], v[116:119], v[72:75]
    ds_read_b128 v[252:255], v11 offset:18432
    s_waitcnt lgkmcnt(8)
    v_mfma_f32_16x16x32_bf16 v[52:55], v[132:135], v[240:243], v[52:55]
    ds_read_b128 v[120:123], v13 offset:16384
    v_mfma_f32_16x16x32_bf16 v[60:63], v[132:135], v[244:247], v[60:63]
    ds_read_b128 v[124:127], v13 offset:18432
    v_mfma_f32_16x16x32_bf16 v[68:71], v[132:135], v[112:115], v[68:71]
    ds_read_b64_tr_b16 v[148:149], v15 offset:20480
    v_mfma_f32_16x16x32_bf16 v[76:79], v[132:135], v[116:119], v[76:79]
    ds_read_b64_tr_b16 v[150:151], v15 offset:20992
    s_waitcnt lgkmcnt(10)
    v_mfma_f32_16x16x32_bf16 v[80:83], v[136:139], v[240:243], v[80:83]
    ds_read_b64_tr_b16 v[152:153], v14 offset:28672
    v_mfma_f32_16x16x32_bf16 v[88:91], v[136:139], v[244:247], v[88:91]
    ds_read_b64_tr_b16 v[154:155], v14 offset:29184
    v_mfma_f32_16x16x32_bf16 v[96:99], v[136:139], v[112:115], v[96:99]
    ds_read_b64_tr_b16 v[156:157], v15 offset:28672
    v_mfma_f32_16x16x32_bf16 v[104:107], v[136:139], v[116:119], v[104:107]
    ds_read_b64_tr_b16 v[158:159], v15 offset:29184
    s_waitcnt lgkmcnt(12)
    v_mfma_f32_16x16x32_bf16 v[84:87], v[140:143], v[240:243], v[84:87]
    v_mfma_f32_16x16x32_bf16 v[92:95], v[140:143], v[244:247], v[92:95]
    v_mfma_f32_16x16x32_bf16 v[100:103], v[140:143], v[112:115], v[100:103]
    v_mfma_f32_16x16x32_bf16 v[108:111], v[140:143], v[116:119], v[108:111]
    s_waitcnt lgkmcnt(9)
    v_mfma_f32_16x16x32_bf16 v[48:51], v[144:147], v[248:251], v[48:51]
    s_waitcnt lgkmcnt(8)
    v_mfma_f32_16x16x32_bf16 v[56:59], v[144:147], v[252:255], v[56:59]
    s_waitcnt lgkmcnt(7)
    v_mfma_f32_16x16x32_bf16 v[64:67], v[144:147], v[120:123], v[64:67]
    s_waitcnt lgkmcnt(6)
    v_mfma_f32_16x16x32_bf16 v[72:75], v[144:147], v[124:127], v[72:75]
    s_waitcnt lgkmcnt(0)
    s_barrier
    v_mfma_f32_16x16x32_bf16 v[52:55], v[148:151], v[248:251], v[52:55]
    ds_read_b128 v[240:243], v10 offset:32768
    v_mfma_f32_16x16x32_bf16 v[60:63], v[148:151], v[252:255], v[60:63]
    ds_read_b64_tr_b16 v[128:129], v14 offset:32768
    v_mfma_f32_16x16x32_bf16 v[68:71], v[148:151], v[120:123], v[68:71]
    ds_read_b64_tr_b16 v[130:131], v14 offset:33280
    v_mfma_f32_16x16x32_bf16 v[76:79], v[148:151], v[124:127], v[76:79]
    ds_read_b128 v[244:247], v10 offset:34816
    v_mfma_f32_16x16x32_bf16 v[80:83], v[152:155], v[248:251], v[80:83]
    ds_read_b128 v[112:115], v12 offset:32768
    v_mfma_f32_16x16x32_bf16 v[88:91], v[152:155], v[252:255], v[88:91]
    ds_read_b128 v[116:119], v12 offset:34816
    v_mfma_f32_16x16x32_bf16 v[96:99], v[152:155], v[120:123], v[96:99]
    ds_read_b64_tr_b16 v[132:133], v15 offset:32768
    v_mfma_f32_16x16x32_bf16 v[104:107], v[152:155], v[124:127], v[104:107]
    ds_read_b64_tr_b16 v[134:135], v15 offset:33280
    v_mfma_f32_16x16x32_bf16 v[84:87], v[156:159], v[248:251], v[84:87]
    ds_read_b64_tr_b16 v[136:137], v14 offset:40960
    v_mfma_f32_16x16x32_bf16 v[92:95], v[156:159], v[252:255], v[92:95]
    ds_read_b64_tr_b16 v[138:139], v14 offset:41472
    v_mfma_f32_16x16x32_bf16 v[100:103], v[156:159], v[120:123], v[100:103]
    ds_read_b64_tr_b16 v[140:141], v15 offset:40960
    v_mfma_f32_16x16x32_bf16 v[108:111], v[156:159], v[124:127], v[108:111]
    ds_read_b64_tr_b16 v[142:143], v15 offset:41472
    s_waitcnt lgkmcnt(9)
    v_mfma_f32_16x16x32_bf16 v[48:51], v[128:131], v[240:243], v[48:51]
    ds_read_b128 v[248:251], v11 offset:32768
    s_waitcnt lgkmcnt(9)
    v_mfma_f32_16x16x32_bf16 v[56:59], v[128:131], v[244:247], v[56:59]
    ds_read_b64_tr_b16 v[144:145], v14 offset:36864
    s_waitcnt lgkmcnt(9)
    v_mfma_f32_16x16x32_bf16 v[64:67], v[128:131], v[112:115], v[64:67]
    ds_read_b64_tr_b16 v[146:147], v14 offset:37376
    s_waitcnt lgkmcnt(9)
    v_mfma_f32_16x16x32_bf16 v[72:75], v[128:131], v[116:119], v[72:75]
    ds_read_b128 v[252:255], v11 offset:34816
    s_waitcnt lgkmcnt(8)
    v_mfma_f32_16x16x32_bf16 v[52:55], v[132:135], v[240:243], v[52:55]
    ds_read_b128 v[120:123], v13 offset:32768
    v_mfma_f32_16x16x32_bf16 v[60:63], v[132:135], v[244:247], v[60:63]
    ds_read_b128 v[124:127], v13 offset:34816
    v_mfma_f32_16x16x32_bf16 v[68:71], v[132:135], v[112:115], v[68:71]
    ds_read_b64_tr_b16 v[148:149], v15 offset:36864
    v_mfma_f32_16x16x32_bf16 v[76:79], v[132:135], v[116:119], v[76:79]
    ds_read_b64_tr_b16 v[150:151], v15 offset:37376
    s_waitcnt lgkmcnt(10)
    v_mfma_f32_16x16x32_bf16 v[80:83], v[136:139], v[240:243], v[80:83]
    ds_read_b64_tr_b16 v[152:153], v14 offset:45056
    v_mfma_f32_16x16x32_bf16 v[88:91], v[136:139], v[244:247], v[88:91]
    ds_read_b64_tr_b16 v[154:155], v14 offset:45568
    v_mfma_f32_16x16x32_bf16 v[96:99], v[136:139], v[112:115], v[96:99]
    ds_read_b64_tr_b16 v[156:157], v15 offset:45056
    v_mfma_f32_16x16x32_bf16 v[104:107], v[136:139], v[116:119], v[104:107]
    ds_read_b64_tr_b16 v[158:159], v15 offset:45568
    s_waitcnt lgkmcnt(12)
    v_mfma_f32_16x16x32_bf16 v[84:87], v[140:143], v[240:243], v[84:87]
    ds_read_b64_tr_b16 v[24:25], v17 offset:0
    v_mfma_f32_16x16x32_bf16 v[92:95], v[140:143], v[244:247], v[92:95]
    ds_read_b64_tr_b16 v[26:27], v17 offset:256
    v_mfma_f32_16x16x32_bf16 v[100:103], v[140:143], v[112:115], v[100:103]
    ds_read_b64_tr_b16 v[28:29], v17 offset:1024
    v_mfma_f32_16x16x32_bf16 v[108:111], v[140:143], v[116:119], v[108:111]
    ds_read_b64_tr_b16 v[30:31], v17 offset:1280
    s_waitcnt lgkmcnt(13)
    v_mfma_f32_16x16x32_bf16 v[48:51], v[144:147], v[248:251], v[48:51]
    s_waitcnt lgkmcnt(12)
    v_mfma_f32_16x16x32_bf16 v[56:59], v[144:147], v[252:255], v[56:59]
    s_waitcnt lgkmcnt(11)
    v_mfma_f32_16x16x32_bf16 v[64:67], v[144:147], v[120:123], v[64:67]
    s_waitcnt lgkmcnt(10)
    v_mfma_f32_16x16x32_bf16 v[72:75], v[144:147], v[124:127], v[72:75]
    s_waitcnt lgkmcnt(0)
    s_barrier
    v_mfma_f32_16x16x32_bf16 v[52:55], v[148:151], v[248:251], v[52:55]
    ds_read_b128 v[240:243], v10 offset:0
    v_mfma_f32_16x16x32_bf16 v[60:63], v[148:151], v[252:255], v[60:63]
    ds_read_b64_tr_b16 v[128:129], v14 offset:0
    v_mfma_f32_16x16x32_bf16 v[68:71], v[148:151], v[120:123], v[68:71]
    ds_read_b64_tr_b16 v[130:131], v14 offset:512
    v_mfma_f32_16x16x32_bf16 v[76:79], v[148:151], v[124:127], v[76:79]
    ds_read_b128 v[244:247], v10 offset:2048
    v_mfma_f32_16x16x32_bf16 v[80:83], v[152:155], v[248:251], v[80:83]
    ds_read_b128 v[112:115], v12 offset:0
    v_mfma_f32_16x16x32_bf16 v[88:91], v[152:155], v[252:255], v[88:91]
    ds_read_b128 v[116:119], v12 offset:2048
    v_mfma_f32_16x16x32_bf16 v[96:99], v[152:155], v[120:123], v[96:99]
    ds_read_b64_tr_b16 v[132:133], v15 offset:0
    v_mfma_f32_16x16x32_bf16 v[104:107], v[152:155], v[124:127], v[104:107]
    ds_read_b64_tr_b16 v[134:135], v15 offset:512
    v_mfma_f32_16x16x32_bf16 v[84:87], v[156:159], v[248:251], v[84:87]
    ds_read_b64_tr_b16 v[136:137], v14 offset:8192
    v_mfma_f32_16x16x32_bf16 v[92:95], v[156:159], v[252:255], v[92:95]
    ds_read_b64_tr_b16 v[138:139], v14 offset:8704
    v_mfma_f32_16x16x32_bf16 v[100:103], v[156:159], v[120:123], v[100:103]
    ds_read_b64_tr_b16 v[140:141], v15 offset:8192
    v_mfma_f32_16x16x32_bf16 v[108:111], v[156:159], v[124:127], v[108:111]
    ds_read_b64_tr_b16 v[142:143], v15 offset:8704
    s_waitcnt lgkmcnt(9)
    v_mfma_f32_16x16x32_bf16 v[48:51], v[128:131], v[240:243], v[48:51]
    ds_read_b128 v[248:251], v11 offset:0
    s_waitcnt lgkmcnt(9)
    v_mfma_f32_16x16x32_bf16 v[56:59], v[128:131], v[244:247], v[56:59]
    ds_read_b64_tr_b16 v[144:145], v14 offset:4096
    s_waitcnt lgkmcnt(9)
    v_mfma_f32_16x16x32_bf16 v[64:67], v[128:131], v[112:115], v[64:67]
    ds_read_b64_tr_b16 v[146:147], v14 offset:4608
    s_waitcnt lgkmcnt(9)
    v_mfma_f32_16x16x32_bf16 v[72:75], v[128:131], v[116:119], v[72:75]
    ds_read_b128 v[252:255], v11 offset:2048
    s_waitcnt lgkmcnt(8)
    v_mfma_f32_16x16x32_bf16 v[52:55], v[132:135], v[240:243], v[52:55]
    ds_read_b128 v[120:123], v13 offset:0
    v_mfma_f32_16x16x32_bf16 v[60:63], v[132:135], v[244:247], v[60:63]
    ds_read_b128 v[124:127], v13 offset:2048
    v_mfma_f32_16x16x32_bf16 v[68:71], v[132:135], v[112:115], v[68:71]
    ds_read_b64_tr_b16 v[148:149], v15 offset:4096
    v_mfma_f32_16x16x32_bf16 v[76:79], v[132:135], v[116:119], v[76:79]
    ds_read_b64_tr_b16 v[150:151], v15 offset:4608
    s_waitcnt lgkmcnt(10)
    v_mfma_f32_16x16x32_bf16 v[80:83], v[136:139], v[240:243], v[80:83]
    ds_read_b64_tr_b16 v[152:153], v14 offset:12288
    v_mfma_f32_16x16x32_bf16 v[88:91], v[136:139], v[244:247], v[88:91]
    ds_read_b64_tr_b16 v[154:155], v14 offset:12800
    v_mfma_f32_16x16x32_bf16 v[96:99], v[136:139], v[112:115], v[96:99]
    ds_read_b64_tr_b16 v[156:157], v15 offset:12288
    v_mfma_f32_16x16x32_bf16 v[104:107], v[136:139], v[116:119], v[104:107]
    ds_read_b64_tr_b16 v[158:159], v15 offset:12800
    s_waitcnt lgkmcnt(12)
    v_mfma_f32_16x16x32_bf16 v[84:87], v[140:143], v[240:243], v[84:87]
    v_mfma_f32_16x16x32_bf16 v[92:95], v[140:143], v[244:247], v[92:95]
    v_mfma_f32_16x16x32_bf16 v[100:103], v[140:143], v[112:115], v[100:103]
    v_mfma_f32_16x16x32_bf16 v[108:111], v[140:143], v[116:119], v[108:111]
    s_waitcnt lgkmcnt(9)
    v_mfma_f32_16x16x32_bf16 v[48:51], v[144:147], v[248:251], v[48:51]
    s_waitcnt lgkmcnt(8)
    v_mfma_f32_16x16x32_bf16 v[56:59], v[144:147], v[252:255], v[56:59]
    s_waitcnt lgkmcnt(7)
    v_mfma_f32_16x16x32_bf16 v[64:67], v[144:147], v[120:123], v[64:67]
    s_waitcnt lgkmcnt(6)
    v_mfma_f32_16x16x32_bf16 v[72:75], v[144:147], v[124:127], v[72:75]
    s_waitcnt lgkmcnt(0)
    s_barrier
    v_mfma_f32_16x16x32_bf16 v[52:55], v[148:151], v[248:251], v[52:55]
    ds_read_b128 v[240:243], v10 offset:16384
    v_mfma_f32_16x16x32_bf16 v[60:63], v[148:151], v[252:255], v[60:63]
    ds_read_b64_tr_b16 v[128:129], v14 offset:16384
    v_mfma_f32_16x16x32_bf16 v[68:71], v[148:151], v[120:123], v[68:71]
    ds_read_b64_tr_b16 v[130:131], v14 offset:16896
    v_mfma_f32_16x16x32_bf16 v[76:79], v[148:151], v[124:127], v[76:79]
    ds_read_b128 v[244:247], v10 offset:18432
    v_mfma_f32_16x16x32_bf16 v[80:83], v[152:155], v[248:251], v[80:83]
    ds_read_b128 v[112:115], v12 offset:16384
    v_mfma_f32_16x16x32_bf16 v[88:91], v[152:155], v[252:255], v[88:91]
    ds_read_b128 v[116:119], v12 offset:18432
    v_mfma_f32_16x16x32_bf16 v[96:99], v[152:155], v[120:123], v[96:99]
    ds_read_b64_tr_b16 v[132:133], v15 offset:16384
    v_mfma_f32_16x16x32_bf16 v[104:107], v[152:155], v[124:127], v[104:107]
    ds_read_b64_tr_b16 v[134:135], v15 offset:16896
    v_mfma_f32_16x16x32_bf16 v[84:87], v[156:159], v[248:251], v[84:87]
    ds_read_b64_tr_b16 v[136:137], v14 offset:24576
    v_mfma_f32_16x16x32_bf16 v[92:95], v[156:159], v[252:255], v[92:95]
    ds_read_b64_tr_b16 v[138:139], v14 offset:25088
    v_mfma_f32_16x16x32_bf16 v[100:103], v[156:159], v[120:123], v[100:103]
    ds_read_b64_tr_b16 v[140:141], v15 offset:24576
    v_mfma_f32_16x16x32_bf16 v[108:111], v[156:159], v[124:127], v[108:111]
    ds_read_b64_tr_b16 v[142:143], v15 offset:25088
    s_waitcnt lgkmcnt(9)
    v_mfma_f32_16x16x32_bf16 v[48:51], v[128:131], v[240:243], v[48:51]
    ds_read_b128 v[248:251], v11 offset:16384
    s_waitcnt lgkmcnt(9)
    v_mfma_f32_16x16x32_bf16 v[56:59], v[128:131], v[244:247], v[56:59]
    ds_read_b64_tr_b16 v[144:145], v14 offset:20480
    s_waitcnt lgkmcnt(9)
    v_mfma_f32_16x16x32_bf16 v[64:67], v[128:131], v[112:115], v[64:67]
    ds_read_b64_tr_b16 v[146:147], v14 offset:20992
    s_waitcnt lgkmcnt(9)
    v_mfma_f32_16x16x32_bf16 v[72:75], v[128:131], v[116:119], v[72:75]
    ds_read_b128 v[252:255], v11 offset:18432
    s_waitcnt lgkmcnt(8)
    v_mfma_f32_16x16x32_bf16 v[52:55], v[132:135], v[240:243], v[52:55]
    ds_read_b128 v[120:123], v13 offset:16384
    v_mfma_f32_16x16x32_bf16 v[60:63], v[132:135], v[244:247], v[60:63]
    ds_read_b128 v[124:127], v13 offset:18432
    v_mfma_f32_16x16x32_bf16 v[68:71], v[132:135], v[112:115], v[68:71]
    ds_read_b64_tr_b16 v[148:149], v15 offset:20480
    v_mfma_f32_16x16x32_bf16 v[76:79], v[132:135], v[116:119], v[76:79]
    ds_read_b64_tr_b16 v[150:151], v15 offset:20992
    s_waitcnt lgkmcnt(10)
    v_mfma_f32_16x16x32_bf16 v[80:83], v[136:139], v[240:243], v[80:83]
    ds_read_b64_tr_b16 v[152:153], v14 offset:28672
    v_mfma_f32_16x16x32_bf16 v[88:91], v[136:139], v[244:247], v[88:91]
    ds_read_b64_tr_b16 v[154:155], v14 offset:29184
    v_mfma_f32_16x16x32_bf16 v[96:99], v[136:139], v[112:115], v[96:99]
    ds_read_b64_tr_b16 v[156:157], v15 offset:28672
    v_mfma_f32_16x16x32_bf16 v[104:107], v[136:139], v[116:119], v[104:107]
    ds_read_b64_tr_b16 v[158:159], v15 offset:29184
    s_waitcnt lgkmcnt(12)
    v_mfma_f32_16x16x32_bf16 v[84:87], v[140:143], v[240:243], v[84:87]
    v_mfma_f32_16x16x32_bf16 v[92:95], v[140:143], v[244:247], v[92:95]
    v_mfma_f32_16x16x32_bf16 v[100:103], v[140:143], v[112:115], v[100:103]
    v_mfma_f32_16x16x32_bf16 v[108:111], v[140:143], v[116:119], v[108:111]
    s_waitcnt lgkmcnt(9)
    v_mfma_f32_16x16x32_bf16 v[48:51], v[144:147], v[248:251], v[48:51]
    s_waitcnt lgkmcnt(8)
    v_mfma_f32_16x16x32_bf16 v[56:59], v[144:147], v[252:255], v[56:59]
    s_waitcnt lgkmcnt(7)
    v_mfma_f32_16x16x32_bf16 v[64:67], v[144:147], v[120:123], v[64:67]
    s_waitcnt lgkmcnt(6)
    v_mfma_f32_16x16x32_bf16 v[72:75], v[144:147], v[124:127], v[72:75]
    s_waitcnt lgkmcnt(0)
    s_barrier
    v_mfma_f32_16x16x32_bf16 v[52:55], v[148:151], v[248:251], v[52:55]
    ds_read_b128 v[240:243], v10 offset:32768
    v_mfma_f32_16x16x32_bf16 v[60:63], v[148:151], v[252:255], v[60:63]
    ds_read_b64_tr_b16 v[128:129], v14 offset:32768
    v_mfma_f32_16x16x32_bf16 v[68:71], v[148:151], v[120:123], v[68:71]
    ds_read_b64_tr_b16 v[130:131], v14 offset:33280
    v_mfma_f32_16x16x32_bf16 v[76:79], v[148:151], v[124:127], v[76:79]
    ds_read_b128 v[244:247], v10 offset:34816
    v_mfma_f32_16x16x32_bf16 v[80:83], v[152:155], v[248:251], v[80:83]
    ds_read_b128 v[112:115], v12 offset:32768
    v_mfma_f32_16x16x32_bf16 v[88:91], v[152:155], v[252:255], v[88:91]
    ds_read_b128 v[116:119], v12 offset:34816
    v_mfma_f32_16x16x32_bf16 v[96:99], v[152:155], v[120:123], v[96:99]
    ds_read_b64_tr_b16 v[132:133], v15 offset:32768
    v_mfma_f32_16x16x32_bf16 v[104:107], v[152:155], v[124:127], v[104:107]
    ds_read_b64_tr_b16 v[134:135], v15 offset:33280
    v_mfma_f32_16x16x32_bf16 v[84:87], v[156:159], v[248:251], v[84:87]
    ds_read_b64_tr_b16 v[136:137], v14 offset:40960
    v_mfma_f32_16x16x32_bf16 v[92:95], v[156:159], v[252:255], v[92:95]
    ds_read_b64_tr_b16 v[138:139], v14 offset:41472
    v_mfma_f32_16x16x32_bf16 v[100:103], v[156:159], v[120:123], v[100:103]
    ds_read_b64_tr_b16 v[140:141], v15 offset:40960
    v_mfma_f32_16x16x32_bf16 v[108:111], v[156:159], v[124:127], v[108:111]
    ds_read_b64_tr_b16 v[142:143], v15 offset:41472
    s_waitcnt lgkmcnt(9)
    v_mfma_f32_16x16x32_bf16 v[48:51], v[128:131], v[240:243], v[48:51]
    ds_read_b128 v[248:251], v11 offset:32768
    s_waitcnt lgkmcnt(9)
    v_mfma_f32_16x16x32_bf16 v[56:59], v[128:131], v[244:247], v[56:59]
    ds_read_b64_tr_b16 v[144:145], v14 offset:36864
    s_waitcnt lgkmcnt(9)
    v_mfma_f32_16x16x32_bf16 v[64:67], v[128:131], v[112:115], v[64:67]
    ds_read_b64_tr_b16 v[146:147], v14 offset:37376
    s_waitcnt lgkmcnt(9)
    v_mfma_f32_16x16x32_bf16 v[72:75], v[128:131], v[116:119], v[72:75]
    ds_read_b128 v[252:255], v11 offset:34816
    s_waitcnt lgkmcnt(8)
    v_mfma_f32_16x16x32_bf16 v[52:55], v[132:135], v[240:243], v[52:55]
    ds_read_b128 v[120:123], v13 offset:32768
    v_mfma_f32_16x16x32_bf16 v[60:63], v[132:135], v[244:247], v[60:63]
    ds_read_b128 v[124:127], v13 offset:34816
    v_mfma_f32_16x16x32_bf16 v[68:71], v[132:135], v[112:115], v[68:71]
    ds_read_b64_tr_b16 v[148:149], v15 offset:36864
    v_mfma_f32_16x16x32_bf16 v[76:79], v[132:135], v[116:119], v[76:79]
    ds_read_b64_tr_b16 v[150:151], v15 offset:37376
    s_waitcnt lgkmcnt(10)
    v_mfma_f32_16x16x32_bf16 v[80:83], v[136:139], v[240:243], v[80:83]
    ds_read_b64_tr_b16 v[152:153], v14 offset:45056
    v_mfma_f32_16x16x32_bf16 v[88:91], v[136:139], v[244:247], v[88:91]
    ds_read_b64_tr_b16 v[154:155], v14 offset:45568
    v_mfma_f32_16x16x32_bf16 v[96:99], v[136:139], v[112:115], v[96:99]
    ds_read_b64_tr_b16 v[156:157], v15 offset:45056
    v_mfma_f32_16x16x32_bf16 v[104:107], v[136:139], v[116:119], v[104:107]
    ds_read_b64_tr_b16 v[158:159], v15 offset:45568
    s_waitcnt lgkmcnt(12)
    v_mfma_f32_16x16x32_bf16 v[84:87], v[140:143], v[240:243], v[84:87]
    v_mfma_f32_16x16x32_bf16 v[92:95], v[140:143], v[244:247], v[92:95]
    v_mfma_f32_16x16x32_bf16 v[100:103], v[140:143], v[112:115], v[100:103]
    v_mfma_f32_16x16x32_bf16 v[108:111], v[140:143], v[116:119], v[108:111]
    s_waitcnt lgkmcnt(9)
    v_mfma_f32_16x16x32_bf16 v[48:51], v[144:147], v[248:251], v[48:51]
    s_waitcnt lgkmcnt(8)
    v_mfma_f32_16x16x32_bf16 v[56:59], v[144:147], v[252:255], v[56:59]
    s_waitcnt lgkmcnt(7)
    v_mfma_f32_16x16x32_bf16 v[64:67], v[144:147], v[120:123], v[64:67]
    s_waitcnt lgkmcnt(6)
    v_mfma_f32_16x16x32_bf16 v[72:75], v[144:147], v[124:127], v[72:75]
    s_waitcnt lgkmcnt(0)
    s_barrier
    v_mfma_f32_16x16x32_bf16 v[52:55], v[148:151], v[248:251], v[52:55]
    ds_read_b128 v[240:243], v10 offset:0
    v_mfma_f32_16x16x32_bf16 v[60:63], v[148:151], v[252:255], v[60:63]
    ds_read_b64_tr_b16 v[128:129], v14 offset:0
    v_mfma_f32_16x16x32_bf16 v[68:71], v[148:151], v[120:123], v[68:71]
    ds_read_b64_tr_b16 v[130:131], v14 offset:512
    v_mfma_f32_16x16x32_bf16 v[76:79], v[148:151], v[124:127], v[76:79]
    ds_read_b128 v[244:247], v10 offset:2048
    v_mfma_f32_16x16x32_bf16 v[80:83], v[152:155], v[248:251], v[80:83]
    ds_read_b128 v[112:115], v12 offset:0
    v_mfma_f32_16x16x32_bf16 v[88:91], v[152:155], v[252:255], v[88:91]
    ds_read_b128 v[116:119], v12 offset:2048
    v_mfma_f32_16x16x32_bf16 v[96:99], v[152:155], v[120:123], v[96:99]
    ds_read_b64_tr_b16 v[132:133], v15 offset:0
    v_mfma_f32_16x16x32_bf16 v[104:107], v[152:155], v[124:127], v[104:107]
    ds_read_b64_tr_b16 v[134:135], v15 offset:512
    v_mfma_f32_16x16x32_bf16 v[84:87], v[156:159], v[248:251], v[84:87]
    ds_read_b64_tr_b16 v[136:137], v14 offset:8192
    v_mfma_f32_16x16x32_bf16 v[92:95], v[156:159], v[252:255], v[92:95]
    ds_read_b64_tr_b16 v[138:139], v14 offset:8704
    v_mfma_f32_16x16x32_bf16 v[100:103], v[156:159], v[120:123], v[100:103]
    ds_read_b64_tr_b16 v[140:141], v15 offset:8192
    v_mfma_f32_16x16x32_bf16 v[108:111], v[156:159], v[124:127], v[108:111]
    ds_read_b64_tr_b16 v[142:143], v15 offset:8704
    s_waitcnt lgkmcnt(9)
    v_mfma_f32_16x16x32_bf16 v[48:51], v[128:131], v[240:243], v[48:51]
    ds_read_b128 v[248:251], v11 offset:0
    s_waitcnt lgkmcnt(9)
    v_mfma_f32_16x16x32_bf16 v[56:59], v[128:131], v[244:247], v[56:59]
    ds_read_b64_tr_b16 v[144:145], v14 offset:4096
    s_waitcnt lgkmcnt(9)
    v_mfma_f32_16x16x32_bf16 v[64:67], v[128:131], v[112:115], v[64:67]
    ds_read_b64_tr_b16 v[146:147], v14 offset:4608
    s_waitcnt lgkmcnt(9)
    v_mfma_f32_16x16x32_bf16 v[72:75], v[128:131], v[116:119], v[72:75]
    ds_read_b128 v[252:255], v11 offset:2048
    s_waitcnt lgkmcnt(8)
    v_mfma_f32_16x16x32_bf16 v[52:55], v[132:135], v[240:243], v[52:55]
    ds_read_b128 v[120:123], v13 offset:0
    v_mfma_f32_16x16x32_bf16 v[60:63], v[132:135], v[244:247], v[60:63]
    ds_read_b128 v[124:127], v13 offset:2048
    v_mfma_f32_16x16x32_bf16 v[68:71], v[132:135], v[112:115], v[68:71]
    ds_read_b64_tr_b16 v[148:149], v15 offset:4096
    v_mfma_f32_16x16x32_bf16 v[76:79], v[132:135], v[116:119], v[76:79]
    ds_read_b64_tr_b16 v[150:151], v15 offset:4608
    s_waitcnt lgkmcnt(10)
    v_mfma_f32_16x16x32_bf16 v[80:83], v[136:139], v[240:243], v[80:83]
    ds_read_b64_tr_b16 v[152:153], v14 offset:12288
    v_mfma_f32_16x16x32_bf16 v[88:91], v[136:139], v[244:247], v[88:91]
    ds_read_b64_tr_b16 v[154:155], v14 offset:12800
    v_mfma_f32_16x16x32_bf16 v[96:99], v[136:139], v[112:115], v[96:99]
    ds_read_b64_tr_b16 v[156:157], v15 offset:12288
    v_mfma_f32_16x16x32_bf16 v[104:107], v[136:139], v[116:119], v[104:107]
    ds_read_b64_tr_b16 v[158:159], v15 offset:12800
    s_waitcnt lgkmcnt(12)
    v_mfma_f32_16x16x32_bf16 v[84:87], v[140:143], v[240:243], v[84:87]
    v_mfma_f32_16x16x32_bf16 v[92:95], v[140:143], v[244:247], v[92:95]
    v_mfma_f32_16x16x32_bf16 v[100:103], v[140:143], v[112:115], v[100:103]
    v_mfma_f32_16x16x32_bf16 v[108:111], v[140:143], v[116:119], v[108:111]
    s_waitcnt lgkmcnt(9)
    v_mfma_f32_16x16x32_bf16 v[48:51], v[144:147], v[248:251], v[48:51]
    s_waitcnt lgkmcnt(8)
    v_mfma_f32_16x16x32_bf16 v[56:59], v[144:147], v[252:255], v[56:59]
    s_waitcnt lgkmcnt(7)
    v_mfma_f32_16x16x32_bf16 v[64:67], v[144:147], v[120:123], v[64:67]
    s_waitcnt lgkmcnt(6)
    v_mfma_f32_16x16x32_bf16 v[72:75], v[144:147], v[124:127], v[72:75]
    s_waitcnt lgkmcnt(0)
    s_barrier
    v_mfma_f32_16x16x32_bf16 v[52:55], v[148:151], v[248:251], v[52:55]
    ds_read_b128 v[240:243], v10 offset:16384
    v_mfma_f32_16x16x32_bf16 v[60:63], v[148:151], v[252:255], v[60:63]
    ds_read_b64_tr_b16 v[128:129], v14 offset:16384
    v_mfma_f32_16x16x32_bf16 v[68:71], v[148:151], v[120:123], v[68:71]
    ds_read_b64_tr_b16 v[130:131], v14 offset:16896
    v_mfma_f32_16x16x32_bf16 v[76:79], v[148:151], v[124:127], v[76:79]
    ds_read_b128 v[244:247], v10 offset:18432
    v_mfma_f32_16x16x32_bf16 v[80:83], v[152:155], v[248:251], v[80:83]
    ds_read_b128 v[112:115], v12 offset:16384
    v_mfma_f32_16x16x32_bf16 v[88:91], v[152:155], v[252:255], v[88:91]
    ds_read_b128 v[116:119], v12 offset:18432
    v_mfma_f32_16x16x32_bf16 v[96:99], v[152:155], v[120:123], v[96:99]
    ds_read_b64_tr_b16 v[132:133], v15 offset:16384
    v_mfma_f32_16x16x32_bf16 v[104:107], v[152:155], v[124:127], v[104:107]
    ds_read_b64_tr_b16 v[134:135], v15 offset:16896
    v_mfma_f32_16x16x32_bf16 v[84:87], v[156:159], v[248:251], v[84:87]
    ds_read_b64_tr_b16 v[136:137], v14 offset:24576
    v_mfma_f32_16x16x32_bf16 v[92:95], v[156:159], v[252:255], v[92:95]
    ds_read_b64_tr_b16 v[138:139], v14 offset:25088
    v_mfma_f32_16x16x32_bf16 v[100:103], v[156:159], v[120:123], v[100:103]
    ds_read_b64_tr_b16 v[140:141], v15 offset:24576
    v_mfma_f32_16x16x32_bf16 v[108:111], v[156:159], v[124:127], v[108:111]
    ds_read_b64_tr_b16 v[142:143], v15 offset:25088
    s_waitcnt lgkmcnt(9)
    v_mfma_f32_16x16x32_bf16 v[48:51], v[128:131], v[240:243], v[48:51]
    ds_read_b128 v[248:251], v11 offset:16384
    s_waitcnt lgkmcnt(9)
    v_mfma_f32_16x16x32_bf16 v[56:59], v[128:131], v[244:247], v[56:59]
    ds_read_b64_tr_b16 v[144:145], v14 offset:20480
    s_waitcnt lgkmcnt(9)
    v_mfma_f32_16x16x32_bf16 v[64:67], v[128:131], v[112:115], v[64:67]
    ds_read_b64_tr_b16 v[146:147], v14 offset:20992
    s_waitcnt lgkmcnt(9)
    v_mfma_f32_16x16x32_bf16 v[72:75], v[128:131], v[116:119], v[72:75]
    ds_read_b128 v[252:255], v11 offset:18432
    s_waitcnt lgkmcnt(8)
    v_mfma_f32_16x16x32_bf16 v[52:55], v[132:135], v[240:243], v[52:55]
    ds_read_b128 v[120:123], v13 offset:16384
    v_mfma_f32_16x16x32_bf16 v[60:63], v[132:135], v[244:247], v[60:63]
    ds_read_b128 v[124:127], v13 offset:18432
    v_mfma_f32_16x16x32_bf16 v[68:71], v[132:135], v[112:115], v[68:71]
    ds_read_b64_tr_b16 v[148:149], v15 offset:20480
    v_mfma_f32_16x16x32_bf16 v[76:79], v[132:135], v[116:119], v[76:79]
    ds_read_b64_tr_b16 v[150:151], v15 offset:20992
    s_waitcnt lgkmcnt(10)
    v_mfma_f32_16x16x32_bf16 v[80:83], v[136:139], v[240:243], v[80:83]
    ds_read_b64_tr_b16 v[152:153], v14 offset:28672
    v_mfma_f32_16x16x32_bf16 v[88:91], v[136:139], v[244:247], v[88:91]
    ds_read_b64_tr_b16 v[154:155], v14 offset:29184
    v_mfma_f32_16x16x32_bf16 v[96:99], v[136:139], v[112:115], v[96:99]
    ds_read_b64_tr_b16 v[156:157], v15 offset:28672
    v_mfma_f32_16x16x32_bf16 v[104:107], v[136:139], v[116:119], v[104:107]
    ds_read_b64_tr_b16 v[158:159], v15 offset:29184
    s_waitcnt lgkmcnt(12)
    v_mfma_f32_16x16x32_bf16 v[84:87], v[140:143], v[240:243], v[84:87]
    v_mfma_f32_16x16x32_bf16 v[92:95], v[140:143], v[244:247], v[92:95]
    v_mfma_f32_16x16x32_bf16 v[100:103], v[140:143], v[112:115], v[100:103]
    v_mfma_f32_16x16x32_bf16 v[108:111], v[140:143], v[116:119], v[108:111]
    s_waitcnt lgkmcnt(9)
    v_mfma_f32_16x16x32_bf16 v[48:51], v[144:147], v[248:251], v[48:51]
    s_waitcnt lgkmcnt(8)
    v_mfma_f32_16x16x32_bf16 v[56:59], v[144:147], v[252:255], v[56:59]
    s_waitcnt lgkmcnt(7)
    v_mfma_f32_16x16x32_bf16 v[64:67], v[144:147], v[120:123], v[64:67]
    s_waitcnt lgkmcnt(6)
    v_mfma_f32_16x16x32_bf16 v[72:75], v[144:147], v[124:127], v[72:75]
    s_waitcnt lgkmcnt(0)
    s_barrier
    v_mfma_f32_16x16x32_bf16 v[52:55], v[148:151], v[248:251], v[52:55]
    ds_read_b128 v[240:243], v10 offset:32768
    v_mfma_f32_16x16x32_bf16 v[60:63], v[148:151], v[252:255], v[60:63]
    ds_read_b64_tr_b16 v[128:129], v14 offset:32768
    v_mfma_f32_16x16x32_bf16 v[68:71], v[148:151], v[120:123], v[68:71]
    ds_read_b64_tr_b16 v[130:131], v14 offset:33280
    v_mfma_f32_16x16x32_bf16 v[76:79], v[148:151], v[124:127], v[76:79]
    ds_read_b128 v[244:247], v10 offset:34816
    v_mfma_f32_16x16x32_bf16 v[80:83], v[152:155], v[248:251], v[80:83]
    ds_read_b128 v[112:115], v12 offset:32768
    v_mfma_f32_16x16x32_bf16 v[88:91], v[152:155], v[252:255], v[88:91]
    ds_read_b128 v[116:119], v12 offset:34816
    v_mfma_f32_16x16x32_bf16 v[96:99], v[152:155], v[120:123], v[96:99]
    ds_read_b64_tr_b16 v[132:133], v15 offset:32768
    v_mfma_f32_16x16x32_bf16 v[104:107], v[152:155], v[124:127], v[104:107]
    ds_read_b64_tr_b16 v[134:135], v15 offset:33280
    v_mfma_f32_16x16x32_bf16 v[84:87], v[156:159], v[248:251], v[84:87]
    ds_read_b64_tr_b16 v[136:137], v14 offset:40960
    v_mfma_f32_16x16x32_bf16 v[92:95], v[156:159], v[252:255], v[92:95]
    ds_read_b64_tr_b16 v[138:139], v14 offset:41472
    v_mfma_f32_16x16x32_bf16 v[100:103], v[156:159], v[120:123], v[100:103]
    ds_read_b64_tr_b16 v[140:141], v15 offset:40960
    v_mfma_f32_16x16x32_bf16 v[108:111], v[156:159], v[124:127], v[108:111]
    ds_read_b64_tr_b16 v[142:143], v15 offset:41472
    s_waitcnt lgkmcnt(9)
    v_mfma_f32_16x16x32_bf16 v[48:51], v[128:131], v[240:243], v[48:51]
    ds_read_b128 v[248:251], v11 offset:32768
    s_waitcnt lgkmcnt(9)
    v_mfma_f32_16x16x32_bf16 v[56:59], v[128:131], v[244:247], v[56:59]
    ds_read_b64_tr_b16 v[144:145], v14 offset:36864
    s_waitcnt lgkmcnt(9)
    v_mfma_f32_16x16x32_bf16 v[64:67], v[128:131], v[112:115], v[64:67]
    ds_read_b64_tr_b16 v[146:147], v14 offset:37376
    s_waitcnt lgkmcnt(9)
    v_mfma_f32_16x16x32_bf16 v[72:75], v[128:131], v[116:119], v[72:75]
    ds_read_b128 v[252:255], v11 offset:34816
    s_waitcnt lgkmcnt(8)
    v_mfma_f32_16x16x32_bf16 v[52:55], v[132:135], v[240:243], v[52:55]
    ds_read_b128 v[120:123], v13 offset:32768
    v_mfma_f32_16x16x32_bf16 v[60:63], v[132:135], v[244:247], v[60:63]
    ds_read_b128 v[124:127], v13 offset:34816
    v_mfma_f32_16x16x32_bf16 v[68:71], v[132:135], v[112:115], v[68:71]
    ds_read_b64_tr_b16 v[148:149], v15 offset:36864
    v_mfma_f32_16x16x32_bf16 v[76:79], v[132:135], v[116:119], v[76:79]
    ds_read_b64_tr_b16 v[150:151], v15 offset:37376
    s_waitcnt lgkmcnt(10)
    v_mfma_f32_16x16x32_bf16 v[80:83], v[136:139], v[240:243], v[80:83]
    ds_read_b64_tr_b16 v[152:153], v14 offset:45056
    v_mfma_f32_16x16x32_bf16 v[88:91], v[136:139], v[244:247], v[88:91]
    ds_read_b64_tr_b16 v[154:155], v14 offset:45568
    v_mfma_f32_16x16x32_bf16 v[96:99], v[136:139], v[112:115], v[96:99]
    ds_read_b64_tr_b16 v[156:157], v15 offset:45056
    v_mfma_f32_16x16x32_bf16 v[104:107], v[136:139], v[116:119], v[104:107]
    ds_read_b64_tr_b16 v[158:159], v15 offset:45568
    s_waitcnt lgkmcnt(12)
    v_mfma_f32_16x16x32_bf16 v[84:87], v[140:143], v[240:243], v[84:87]
    v_mfma_f32_16x16x32_bf16 v[92:95], v[140:143], v[244:247], v[92:95]
    v_mfma_f32_16x16x32_bf16 v[100:103], v[140:143], v[112:115], v[100:103]
    v_mfma_f32_16x16x32_bf16 v[108:111], v[140:143], v[116:119], v[108:111]
    s_waitcnt lgkmcnt(9)
    v_mfma_f32_16x16x32_bf16 v[48:51], v[144:147], v[248:251], v[48:51]
    s_waitcnt lgkmcnt(8)
    v_mfma_f32_16x16x32_bf16 v[56:59], v[144:147], v[252:255], v[56:59]
    s_waitcnt lgkmcnt(7)
    v_mfma_f32_16x16x32_bf16 v[64:67], v[144:147], v[120:123], v[64:67]
    s_waitcnt lgkmcnt(6)
    v_mfma_f32_16x16x32_bf16 v[72:75], v[144:147], v[124:127], v[72:75]
    s_waitcnt lgkmcnt(0)
    s_barrier
    v_mfma_f32_16x16x32_bf16 v[52:55], v[148:151], v[248:251], v[52:55]
    ds_read_b128 v[160:163], v10 offset:0
    v_mfma_f32_16x16x32_bf16 v[60:63], v[148:151], v[252:255], v[60:63]
    ds_read_b64_tr_b16 v[128:129], v14 offset:0
    v_mfma_f32_16x16x32_bf16 v[68:71], v[148:151], v[120:123], v[68:71]
    ds_read_b64_tr_b16 v[130:131], v14 offset:512
    v_mfma_f32_16x16x32_bf16 v[76:79], v[148:151], v[124:127], v[76:79]
    ds_read_b128 v[164:167], v10 offset:2048
    v_mfma_f32_16x16x32_bf16 v[80:83], v[152:155], v[248:251], v[80:83]
    ds_read_b128 v[112:115], v12 offset:0
    v_mfma_f32_16x16x32_bf16 v[88:91], v[152:155], v[252:255], v[88:91]
    ds_read_b128 v[116:119], v12 offset:2048
    v_mfma_f32_16x16x32_bf16 v[96:99], v[152:155], v[120:123], v[96:99]
    ds_read_b64_tr_b16 v[132:133], v15 offset:0
    v_mfma_f32_16x16x32_bf16 v[104:107], v[152:155], v[124:127], v[104:107]
    ds_read_b64_tr_b16 v[134:135], v15 offset:512
    v_mfma_f32_16x16x32_bf16 v[84:87], v[156:159], v[248:251], v[84:87]
    ds_read_b64_tr_b16 v[136:137], v14 offset:8192
    v_mfma_f32_16x16x32_bf16 v[92:95], v[156:159], v[252:255], v[92:95]
    ds_read_b64_tr_b16 v[138:139], v14 offset:8704
    v_mfma_f32_16x16x32_bf16 v[100:103], v[156:159], v[120:123], v[100:103]
    ds_read_b64_tr_b16 v[140:141], v15 offset:8192
    v_mfma_f32_16x16x32_bf16 v[108:111], v[156:159], v[124:127], v[108:111]
    ds_read_b64_tr_b16 v[142:143], v15 offset:8704
    s_waitcnt lgkmcnt(9)
    v_mfma_f32_16x16x32_bf16 v[48:51], v[128:131], v[160:163], v[48:51]
    ds_read_b128 v[168:171], v11 offset:0
    s_waitcnt lgkmcnt(9)
    v_mfma_f32_16x16x32_bf16 v[56:59], v[128:131], v[164:167], v[56:59]
    ds_read_b64_tr_b16 v[144:145], v14 offset:4096
    s_waitcnt lgkmcnt(9)
    v_mfma_f32_16x16x32_bf16 v[64:67], v[128:131], v[112:115], v[64:67]
    ds_read_b64_tr_b16 v[146:147], v14 offset:4608
    s_waitcnt lgkmcnt(9)
    v_mfma_f32_16x16x32_bf16 v[72:75], v[128:131], v[116:119], v[72:75]
    ds_read_b128 v[172:175], v11 offset:2048
    s_waitcnt lgkmcnt(8)
    v_mfma_f32_16x16x32_bf16 v[52:55], v[132:135], v[160:163], v[52:55]
    ds_read_b128 v[120:123], v13 offset:0
    v_mfma_f32_16x16x32_bf16 v[60:63], v[132:135], v[164:167], v[60:63]
    ds_read_b128 v[124:127], v13 offset:2048
    v_mfma_f32_16x16x32_bf16 v[68:71], v[132:135], v[112:115], v[68:71]
    ds_read_b64_tr_b16 v[148:149], v15 offset:4096
    v_mfma_f32_16x16x32_bf16 v[76:79], v[132:135], v[116:119], v[76:79]
    ds_read_b64_tr_b16 v[150:151], v15 offset:4608
    s_waitcnt lgkmcnt(10)
    v_mfma_f32_16x16x32_bf16 v[80:83], v[136:139], v[160:163], v[80:83]
    ds_read_b64_tr_b16 v[152:153], v14 offset:12288
    v_mfma_f32_16x16x32_bf16 v[88:91], v[136:139], v[164:167], v[88:91]
    ds_read_b64_tr_b16 v[154:155], v14 offset:12800
    v_mfma_f32_16x16x32_bf16 v[96:99], v[136:139], v[112:115], v[96:99]
    ds_read_b64_tr_b16 v[156:157], v15 offset:12288
    v_mfma_f32_16x16x32_bf16 v[104:107], v[136:139], v[116:119], v[104:107]
    ds_read_b64_tr_b16 v[158:159], v15 offset:12800
    s_waitcnt lgkmcnt(12)
    v_mfma_f32_16x16x32_bf16 v[84:87], v[140:143], v[160:163], v[84:87]
    v_mfma_f32_16x16x32_bf16 v[92:95], v[140:143], v[164:167], v[92:95]
    v_mfma_f32_16x16x32_bf16 v[100:103], v[140:143], v[112:115], v[100:103]
    v_mfma_f32_16x16x32_bf16 v[108:111], v[140:143], v[116:119], v[108:111]
    s_waitcnt lgkmcnt(9)
    v_mfma_f32_16x16x32_bf16 v[48:51], v[144:147], v[168:171], v[48:51]
    s_waitcnt lgkmcnt(8)
    v_mfma_f32_16x16x32_bf16 v[56:59], v[144:147], v[172:175], v[56:59]
    s_waitcnt lgkmcnt(7)
    v_mfma_f32_16x16x32_bf16 v[64:67], v[144:147], v[120:123], v[64:67]
    s_waitcnt lgkmcnt(6)
    v_mfma_f32_16x16x32_bf16 v[72:75], v[144:147], v[124:127], v[72:75]
    s_waitcnt lgkmcnt(0)
    s_barrier
    v_mfma_f32_16x16x32_bf16 v[52:55], v[148:151], v[168:171], v[52:55]
    ds_read_b128 v[176:179], v10 offset:16384
    v_mfma_f32_16x16x32_bf16 v[60:63], v[148:151], v[172:175], v[60:63]
    ds_read_b64_tr_b16 v[128:129], v14 offset:16384
    v_mfma_f32_16x16x32_bf16 v[68:71], v[148:151], v[120:123], v[68:71]
    ds_read_b64_tr_b16 v[130:131], v14 offset:16896
    v_mfma_f32_16x16x32_bf16 v[76:79], v[148:151], v[124:127], v[76:79]
    ds_read_b128 v[180:183], v10 offset:18432
    v_mfma_f32_16x16x32_bf16 v[80:83], v[152:155], v[168:171], v[80:83]
    ds_read_b128 v[112:115], v12 offset:16384
    v_mfma_f32_16x16x32_bf16 v[88:91], v[152:155], v[172:175], v[88:91]
    ds_read_b128 v[116:119], v12 offset:18432
    v_mfma_f32_16x16x32_bf16 v[96:99], v[152:155], v[120:123], v[96:99]
    ds_read_b64_tr_b16 v[132:133], v15 offset:16384
    v_mfma_f32_16x16x32_bf16 v[104:107], v[152:155], v[124:127], v[104:107]
    ds_read_b64_tr_b16 v[134:135], v15 offset:16896
    v_mfma_f32_16x16x32_bf16 v[84:87], v[156:159], v[168:171], v[84:87]
    ds_read_b64_tr_b16 v[136:137], v14 offset:24576
    v_mfma_f32_16x16x32_bf16 v[92:95], v[156:159], v[172:175], v[92:95]
    ds_read_b64_tr_b16 v[138:139], v14 offset:25088
    v_mfma_f32_16x16x32_bf16 v[100:103], v[156:159], v[120:123], v[100:103]
    ds_read_b64_tr_b16 v[140:141], v15 offset:24576
    v_mfma_f32_16x16x32_bf16 v[108:111], v[156:159], v[124:127], v[108:111]
    ds_read_b64_tr_b16 v[142:143], v15 offset:25088
    s_waitcnt lgkmcnt(9)
    v_mfma_f32_16x16x32_bf16 v[48:51], v[128:131], v[176:179], v[48:51]
    ds_read_b128 v[184:187], v11 offset:16384
    s_waitcnt lgkmcnt(9)
    v_mfma_f32_16x16x32_bf16 v[56:59], v[128:131], v[180:183], v[56:59]
    ds_read_b64_tr_b16 v[144:145], v14 offset:20480
    s_waitcnt lgkmcnt(9)
    v_mfma_f32_16x16x32_bf16 v[64:67], v[128:131], v[112:115], v[64:67]
    ds_read_b64_tr_b16 v[146:147], v14 offset:20992
    s_waitcnt lgkmcnt(9)
    v_mfma_f32_16x16x32_bf16 v[72:75], v[128:131], v[116:119], v[72:75]
    ds_read_b128 v[188:191], v11 offset:18432
    s_waitcnt lgkmcnt(8)
    v_mfma_f32_16x16x32_bf16 v[52:55], v[132:135], v[176:179], v[52:55]
    ds_read_b128 v[120:123], v13 offset:16384
    v_mfma_f32_16x16x32_bf16 v[60:63], v[132:135], v[180:183], v[60:63]
    ds_read_b128 v[124:127], v13 offset:18432
    v_mfma_f32_16x16x32_bf16 v[68:71], v[132:135], v[112:115], v[68:71]
    ds_read_b64_tr_b16 v[148:149], v15 offset:20480
    v_mfma_f32_16x16x32_bf16 v[76:79], v[132:135], v[116:119], v[76:79]
    ds_read_b64_tr_b16 v[150:151], v15 offset:20992
    s_waitcnt lgkmcnt(10)
    v_mfma_f32_16x16x32_bf16 v[80:83], v[136:139], v[176:179], v[80:83]
    ds_read_b64_tr_b16 v[152:153], v14 offset:28672
    v_mfma_f32_16x16x32_bf16 v[88:91], v[136:139], v[180:183], v[88:91]
    ds_read_b64_tr_b16 v[154:155], v14 offset:29184
    v_mfma_f32_16x16x32_bf16 v[96:99], v[136:139], v[112:115], v[96:99]
    ds_read_b64_tr_b16 v[156:157], v15 offset:28672
    v_mfma_f32_16x16x32_bf16 v[104:107], v[136:139], v[116:119], v[104:107]
    ds_read_b64_tr_b16 v[158:159], v15 offset:29184
    s_waitcnt lgkmcnt(12)
    v_mfma_f32_16x16x32_bf16 v[84:87], v[140:143], v[176:179], v[84:87]
    v_mfma_f32_16x16x32_bf16 v[92:95], v[140:143], v[180:183], v[92:95]
    v_mfma_f32_16x16x32_bf16 v[100:103], v[140:143], v[112:115], v[100:103]
    v_mfma_f32_16x16x32_bf16 v[108:111], v[140:143], v[116:119], v[108:111]
    s_waitcnt lgkmcnt(9)
    v_mfma_f32_16x16x32_bf16 v[48:51], v[144:147], v[184:187], v[48:51]
    s_waitcnt lgkmcnt(8)
    v_mfma_f32_16x16x32_bf16 v[56:59], v[144:147], v[188:191], v[56:59]
    s_waitcnt lgkmcnt(7)
    v_mfma_f32_16x16x32_bf16 v[64:67], v[144:147], v[120:123], v[64:67]
    s_waitcnt lgkmcnt(6)
    v_mfma_f32_16x16x32_bf16 v[72:75], v[144:147], v[124:127], v[72:75]
    s_waitcnt lgkmcnt(0)
    s_barrier
    v_mfma_f32_16x16x32_bf16 v[52:55], v[148:151], v[184:187], v[52:55]
    ds_read_b128 v[192:195], v10 offset:32768
    v_mfma_f32_16x16x32_bf16 v[60:63], v[148:151], v[188:191], v[60:63]
    ds_read_b64_tr_b16 v[128:129], v14 offset:32768
    v_mfma_f32_16x16x32_bf16 v[68:71], v[148:151], v[120:123], v[68:71]
    ds_read_b64_tr_b16 v[130:131], v14 offset:33280
    v_mfma_f32_16x16x32_bf16 v[76:79], v[148:151], v[124:127], v[76:79]
    ds_read_b128 v[196:199], v10 offset:34816
    v_mfma_f32_16x16x32_bf16 v[80:83], v[152:155], v[184:187], v[80:83]
    ds_read_b128 v[112:115], v12 offset:32768
    v_mfma_f32_16x16x32_bf16 v[88:91], v[152:155], v[188:191], v[88:91]
    ds_read_b128 v[116:119], v12 offset:34816
    v_mfma_f32_16x16x32_bf16 v[96:99], v[152:155], v[120:123], v[96:99]
    ds_read_b64_tr_b16 v[132:133], v15 offset:32768
    v_mfma_f32_16x16x32_bf16 v[104:107], v[152:155], v[124:127], v[104:107]
    ds_read_b64_tr_b16 v[134:135], v15 offset:33280
    v_mfma_f32_16x16x32_bf16 v[84:87], v[156:159], v[184:187], v[84:87]
    ds_read_b64_tr_b16 v[136:137], v14 offset:40960
    v_mfma_f32_16x16x32_bf16 v[92:95], v[156:159], v[188:191], v[92:95]
    ds_read_b64_tr_b16 v[138:139], v14 offset:41472
    v_mfma_f32_16x16x32_bf16 v[100:103], v[156:159], v[120:123], v[100:103]
    ds_read_b64_tr_b16 v[140:141], v15 offset:40960
    v_mfma_f32_16x16x32_bf16 v[108:111], v[156:159], v[124:127], v[108:111]
    ds_read_b64_tr_b16 v[142:143], v15 offset:41472
    s_waitcnt lgkmcnt(9)
    v_mfma_f32_16x16x32_bf16 v[48:51], v[128:131], v[192:195], v[48:51]
    ds_read_b128 v[200:203], v11 offset:32768
    s_waitcnt lgkmcnt(9)
    v_mfma_f32_16x16x32_bf16 v[56:59], v[128:131], v[196:199], v[56:59]
    ds_read_b64_tr_b16 v[144:145], v14 offset:36864
    s_waitcnt lgkmcnt(9)
    v_mfma_f32_16x16x32_bf16 v[64:67], v[128:131], v[112:115], v[64:67]
    ds_read_b64_tr_b16 v[146:147], v14 offset:37376
    s_waitcnt lgkmcnt(9)
    v_mfma_f32_16x16x32_bf16 v[72:75], v[128:131], v[116:119], v[72:75]
    ds_read_b128 v[204:207], v11 offset:34816
    s_waitcnt lgkmcnt(8)
    v_mfma_f32_16x16x32_bf16 v[52:55], v[132:135], v[192:195], v[52:55]
    ds_read_b128 v[120:123], v13 offset:32768
    v_mfma_f32_16x16x32_bf16 v[60:63], v[132:135], v[196:199], v[60:63]
    ds_read_b128 v[124:127], v13 offset:34816
    v_mfma_f32_16x16x32_bf16 v[68:71], v[132:135], v[112:115], v[68:71]
    ds_read_b64_tr_b16 v[148:149], v15 offset:36864
    v_mfma_f32_16x16x32_bf16 v[76:79], v[132:135], v[116:119], v[76:79]
    ds_read_b64_tr_b16 v[150:151], v15 offset:37376
    s_waitcnt lgkmcnt(10)
    v_mfma_f32_16x16x32_bf16 v[80:83], v[136:139], v[192:195], v[80:83]
    ds_read_b64_tr_b16 v[152:153], v14 offset:45056
    v_mfma_f32_16x16x32_bf16 v[88:91], v[136:139], v[196:199], v[88:91]
    ds_read_b64_tr_b16 v[154:155], v14 offset:45568
    v_mfma_f32_16x16x32_bf16 v[96:99], v[136:139], v[112:115], v[96:99]
    ds_read_b64_tr_b16 v[156:157], v15 offset:45056
    v_mfma_f32_16x16x32_bf16 v[104:107], v[136:139], v[116:119], v[104:107]
    ds_read_b64_tr_b16 v[158:159], v15 offset:45568
    s_waitcnt lgkmcnt(12)
    v_mfma_f32_16x16x32_bf16 v[84:87], v[140:143], v[192:195], v[84:87]
    v_mfma_f32_16x16x32_bf16 v[92:95], v[140:143], v[196:199], v[92:95]
    v_mfma_f32_16x16x32_bf16 v[100:103], v[140:143], v[112:115], v[100:103]
    v_mfma_f32_16x16x32_bf16 v[108:111], v[140:143], v[116:119], v[108:111]
    s_waitcnt lgkmcnt(9)
    v_mfma_f32_16x16x32_bf16 v[48:51], v[144:147], v[200:203], v[48:51]
    s_waitcnt lgkmcnt(8)
    v_mfma_f32_16x16x32_bf16 v[56:59], v[144:147], v[204:207], v[56:59]
    s_waitcnt lgkmcnt(7)
    v_mfma_f32_16x16x32_bf16 v[64:67], v[144:147], v[120:123], v[64:67]
    s_waitcnt lgkmcnt(6)
    v_mfma_f32_16x16x32_bf16 v[72:75], v[144:147], v[124:127], v[72:75]
    s_waitcnt lgkmcnt(0)
    s_barrier
    v_mfma_f32_16x16x32_bf16 v[52:55], v[148:151], v[200:203], v[52:55]
    ds_read_b128 v[208:211], v10 offset:0
    v_mfma_f32_16x16x32_bf16 v[60:63], v[148:151], v[204:207], v[60:63]
    ds_read_b64_tr_b16 v[128:129], v14 offset:0
    v_mfma_f32_16x16x32_bf16 v[68:71], v[148:151], v[120:123], v[68:71]
    ds_read_b64_tr_b16 v[130:131], v14 offset:512
    v_mfma_f32_16x16x32_bf16 v[76:79], v[148:151], v[124:127], v[76:79]
    ds_read_b128 v[212:215], v10 offset:2048
    v_mfma_f32_16x16x32_bf16 v[80:83], v[152:155], v[200:203], v[80:83]
    ds_read_b128 v[112:115], v12 offset:0
    v_mfma_f32_16x16x32_bf16 v[88:91], v[152:155], v[204:207], v[88:91]
    ds_read_b128 v[116:119], v12 offset:2048
    v_mfma_f32_16x16x32_bf16 v[96:99], v[152:155], v[120:123], v[96:99]
    ds_read_b64_tr_b16 v[132:133], v15 offset:0
    v_mfma_f32_16x16x32_bf16 v[104:107], v[152:155], v[124:127], v[104:107]
    ds_read_b64_tr_b16 v[134:135], v15 offset:512
    v_mfma_f32_16x16x32_bf16 v[84:87], v[156:159], v[200:203], v[84:87]
    ds_read_b64_tr_b16 v[136:137], v14 offset:8192
    v_mfma_f32_16x16x32_bf16 v[92:95], v[156:159], v[204:207], v[92:95]
    ds_read_b64_tr_b16 v[138:139], v14 offset:8704
    v_mfma_f32_16x16x32_bf16 v[100:103], v[156:159], v[120:123], v[100:103]
    ds_read_b64_tr_b16 v[140:141], v15 offset:8192
    v_mfma_f32_16x16x32_bf16 v[108:111], v[156:159], v[124:127], v[108:111]
    ds_read_b64_tr_b16 v[142:143], v15 offset:8704
    s_waitcnt lgkmcnt(9)
    v_mfma_f32_16x16x32_bf16 v[48:51], v[128:131], v[208:211], v[48:51]
    ds_read_b128 v[216:219], v11 offset:0
    s_waitcnt lgkmcnt(9)
    v_mfma_f32_16x16x32_bf16 v[56:59], v[128:131], v[212:215], v[56:59]
    ds_read_b64_tr_b16 v[144:145], v14 offset:4096
    s_waitcnt lgkmcnt(9)
    v_mfma_f32_16x16x32_bf16 v[64:67], v[128:131], v[112:115], v[64:67]
    ds_read_b64_tr_b16 v[146:147], v14 offset:4608
    s_waitcnt lgkmcnt(9)
    v_mfma_f32_16x16x32_bf16 v[72:75], v[128:131], v[116:119], v[72:75]
    ds_read_b128 v[220:223], v11 offset:2048
    s_waitcnt lgkmcnt(8)
    v_mfma_f32_16x16x32_bf16 v[52:55], v[132:135], v[208:211], v[52:55]
    ds_read_b128 v[120:123], v13 offset:0
    v_mfma_f32_16x16x32_bf16 v[60:63], v[132:135], v[212:215], v[60:63]
    ds_read_b128 v[124:127], v13 offset:2048
    v_mfma_f32_16x16x32_bf16 v[68:71], v[132:135], v[112:115], v[68:71]
    ds_read_b64_tr_b16 v[148:149], v15 offset:4096
    v_mfma_f32_16x16x32_bf16 v[76:79], v[132:135], v[116:119], v[76:79]
    ds_read_b64_tr_b16 v[150:151], v15 offset:4608
    s_waitcnt lgkmcnt(10)
    v_mfma_f32_16x16x32_bf16 v[80:83], v[136:139], v[208:211], v[80:83]
    ds_read_b64_tr_b16 v[152:153], v14 offset:12288
    v_mfma_f32_16x16x32_bf16 v[88:91], v[136:139], v[212:215], v[88:91]
    ds_read_b64_tr_b16 v[154:155], v14 offset:12800
    v_mfma_f32_16x16x32_bf16 v[96:99], v[136:139], v[112:115], v[96:99]
    ds_read_b64_tr_b16 v[156:157], v15 offset:12288
    v_mfma_f32_16x16x32_bf16 v[104:107], v[136:139], v[116:119], v[104:107]
    ds_read_b64_tr_b16 v[158:159], v15 offset:12800
    s_waitcnt lgkmcnt(12)
    v_mfma_f32_16x16x32_bf16 v[84:87], v[140:143], v[208:211], v[84:87]
    v_mfma_f32_16x16x32_bf16 v[92:95], v[140:143], v[212:215], v[92:95]
    s_mov_b32 s47, 458752
    s_mov_b32 exec_hi, 0
    buffer_load_dword v47, v8, s[28:31], s47 offen
    s_mov_b32 exec_hi, -1
    v_mfma_f32_16x16x32_bf16 v[100:103], v[140:143], v[112:115], v[100:103]
    v_mfma_f32_16x16x32_bf16 v[108:111], v[140:143], v[116:119], v[108:111]
    s_waitcnt lgkmcnt(9)
    v_mfma_f32_16x16x32_bf16 v[48:51], v[144:147], v[216:219], v[48:51]
    s_waitcnt lgkmcnt(8)
    v_mfma_f32_16x16x32_bf16 v[56:59], v[144:147], v[220:223], v[56:59]
    s_waitcnt lgkmcnt(7)
    v_mfma_f32_16x16x32_bf16 v[64:67], v[144:147], v[120:123], v[64:67]
    s_waitcnt lgkmcnt(6)
    v_mfma_f32_16x16x32_bf16 v[72:75], v[144:147], v[124:127], v[72:75]
    s_waitcnt lgkmcnt(0)
    s_barrier
    v_mfma_f32_16x16x32_bf16 v[52:55], v[148:151], v[216:219], v[52:55]
    ds_read_b128 v[224:227], v10 offset:16384
    v_mfma_f32_16x16x32_bf16 v[60:63], v[148:151], v[220:223], v[60:63]
    ds_read_b64_tr_b16 v[128:129], v14 offset:16384
    v_mfma_f32_16x16x32_bf16 v[68:71], v[148:151], v[120:123], v[68:71]
    ds_read_b64_tr_b16 v[130:131], v14 offset:16896
    v_mfma_f32_16x16x32_bf16 v[76:79], v[148:151], v[124:127], v[76:79]
    ds_read_b128 v[228:231], v10 offset:18432
    v_mfma_f32_16x16x32_bf16 v[80:83], v[152:155], v[216:219], v[80:83]
    ds_read_b128 v[112:115], v12 offset:16384
    v_mfma_f32_16x16x32_bf16 v[88:91], v[152:155], v[220:223], v[88:91]
    ds_read_b128 v[116:119], v12 offset:18432
    v_mfma_f32_16x16x32_bf16 v[96:99], v[152:155], v[120:123], v[96:99]
    ds_read_b64_tr_b16 v[132:133], v15 offset:16384
    v_mfma_f32_16x16x32_bf16 v[104:107], v[152:155], v[124:127], v[104:107]
    ds_read_b64_tr_b16 v[134:135], v15 offset:16896
    v_mfma_f32_16x16x32_bf16 v[84:87], v[156:159], v[216:219], v[84:87]
    ds_read_b64_tr_b16 v[136:137], v14 offset:24576
    v_mfma_f32_16x16x32_bf16 v[92:95], v[156:159], v[220:223], v[92:95]
    ds_read_b64_tr_b16 v[138:139], v14 offset:25088
    v_mfma_f32_16x16x32_bf16 v[100:103], v[156:159], v[120:123], v[100:103]
    ds_read_b64_tr_b16 v[140:141], v15 offset:24576
    v_mfma_f32_16x16x32_bf16 v[108:111], v[156:159], v[124:127], v[108:111]
    ds_read_b64_tr_b16 v[142:143], v15 offset:25088
    s_waitcnt lgkmcnt(9)
    v_mfma_f32_16x16x32_bf16 v[48:51], v[128:131], v[224:227], v[48:51]
    ds_read_b128 v[232:235], v11 offset:16384
    s_waitcnt lgkmcnt(9)
    v_mfma_f32_16x16x32_bf16 v[56:59], v[128:131], v[228:231], v[56:59]
    ds_read_b64_tr_b16 v[144:145], v14 offset:20480
    s_waitcnt lgkmcnt(9)
    v_mfma_f32_16x16x32_bf16 v[64:67], v[128:131], v[112:115], v[64:67]
    ds_read_b64_tr_b16 v[146:147], v14 offset:20992
    s_waitcnt lgkmcnt(9)
    v_mfma_f32_16x16x32_bf16 v[72:75], v[128:131], v[116:119], v[72:75]
    ds_read_b128 v[236:239], v11 offset:18432
    s_waitcnt lgkmcnt(8)
    v_mfma_f32_16x16x32_bf16 v[52:55], v[132:135], v[224:227], v[52:55]
    ds_read_b128 v[120:123], v13 offset:16384
    v_mfma_f32_16x16x32_bf16 v[60:63], v[132:135], v[228:231], v[60:63]
    ds_read_b128 v[124:127], v13 offset:18432
    v_mfma_f32_16x16x32_bf16 v[68:71], v[132:135], v[112:115], v[68:71]
    ds_read_b64_tr_b16 v[148:149], v15 offset:20480
    v_mfma_f32_16x16x32_bf16 v[76:79], v[132:135], v[116:119], v[76:79]
    ds_read_b64_tr_b16 v[150:151], v15 offset:20992
    s_waitcnt lgkmcnt(10)
    v_mfma_f32_16x16x32_bf16 v[80:83], v[136:139], v[224:227], v[80:83]
    ds_read_b64_tr_b16 v[152:153], v14 offset:28672
    v_mfma_f32_16x16x32_bf16 v[88:91], v[136:139], v[228:231], v[88:91]
    ds_read_b64_tr_b16 v[154:155], v14 offset:29184
    v_mfma_f32_16x16x32_bf16 v[96:99], v[136:139], v[112:115], v[96:99]
    ds_read_b64_tr_b16 v[156:157], v15 offset:28672
    v_mfma_f32_16x16x32_bf16 v[104:107], v[136:139], v[116:119], v[104:107]
    ds_read_b64_tr_b16 v[158:159], v15 offset:29184
    s_waitcnt lgkmcnt(12)
    v_mfma_f32_16x16x32_bf16 v[84:87], v[140:143], v[224:227], v[84:87]
    v_mfma_f32_16x16x32_bf16 v[92:95], v[140:143], v[228:231], v[92:95]
    v_mfma_f32_16x16x32_bf16 v[100:103], v[140:143], v[112:115], v[100:103]
    v_mfma_f32_16x16x32_bf16 v[108:111], v[140:143], v[116:119], v[108:111]
    s_waitcnt lgkmcnt(9)
    v_mfma_f32_16x16x32_bf16 v[48:51], v[144:147], v[232:235], v[48:51]
    s_waitcnt lgkmcnt(8)
    v_mfma_f32_16x16x32_bf16 v[56:59], v[144:147], v[236:239], v[56:59]
    s_waitcnt lgkmcnt(7)
    v_mfma_f32_16x16x32_bf16 v[64:67], v[144:147], v[120:123], v[64:67]
    s_waitcnt lgkmcnt(6)
    v_mfma_f32_16x16x32_bf16 v[72:75], v[144:147], v[124:127], v[72:75]
    s_waitcnt lgkmcnt(0)
    s_barrier
    v_mfma_f32_16x16x32_bf16 v[52:55], v[148:151], v[232:235], v[52:55]
    ds_read_b128 v[240:243], v10 offset:32768
    v_mfma_f32_16x16x32_bf16 v[60:63], v[148:151], v[236:239], v[60:63]
    ds_read_b64_tr_b16 v[128:129], v14 offset:32768
    v_mfma_f32_16x16x32_bf16 v[68:71], v[148:151], v[120:123], v[68:71]
    ds_read_b64_tr_b16 v[130:131], v14 offset:33280
    v_mfma_f32_16x16x32_bf16 v[76:79], v[148:151], v[124:127], v[76:79]
    ds_read_b128 v[244:247], v10 offset:34816
    v_mfma_f32_16x16x32_bf16 v[80:83], v[152:155], v[232:235], v[80:83]
    ds_read_b128 v[112:115], v12 offset:32768
    v_mfma_f32_16x16x32_bf16 v[88:91], v[152:155], v[236:239], v[88:91]
    ds_read_b128 v[116:119], v12 offset:34816
    v_mfma_f32_16x16x32_bf16 v[96:99], v[152:155], v[120:123], v[96:99]
    ds_read_b64_tr_b16 v[132:133], v15 offset:32768
    v_mfma_f32_16x16x32_bf16 v[104:107], v[152:155], v[124:127], v[104:107]
    ds_read_b64_tr_b16 v[134:135], v15 offset:33280
    v_mfma_f32_16x16x32_bf16 v[84:87], v[156:159], v[232:235], v[84:87]
    ds_read_b64_tr_b16 v[136:137], v14 offset:40960
    v_mfma_f32_16x16x32_bf16 v[92:95], v[156:159], v[236:239], v[92:95]
    ds_read_b64_tr_b16 v[138:139], v14 offset:41472
    v_mfma_f32_16x16x32_bf16 v[100:103], v[156:159], v[120:123], v[100:103]
    ds_read_b64_tr_b16 v[140:141], v15 offset:40960
    v_mfma_f32_16x16x32_bf16 v[108:111], v[156:159], v[124:127], v[108:111]
    ds_read_b64_tr_b16 v[142:143], v15 offset:41472
    s_waitcnt lgkmcnt(9)
    v_mfma_f32_16x16x32_bf16 v[48:51], v[128:131], v[240:243], v[48:51]
    ds_read_b128 v[248:251], v11 offset:32768
    s_waitcnt lgkmcnt(9)
    v_mfma_f32_16x16x32_bf16 v[56:59], v[128:131], v[244:247], v[56:59]
    ds_read_b64_tr_b16 v[144:145], v14 offset:36864
    s_waitcnt lgkmcnt(9)
    v_mfma_f32_16x16x32_bf16 v[64:67], v[128:131], v[112:115], v[64:67]
    ds_read_b64_tr_b16 v[146:147], v14 offset:37376
    s_waitcnt lgkmcnt(9)
    v_mfma_f32_16x16x32_bf16 v[72:75], v[128:131], v[116:119], v[72:75]
    ds_read_b128 v[252:255], v11 offset:34816
    s_waitcnt lgkmcnt(8)
    v_mfma_f32_16x16x32_bf16 v[52:55], v[132:135], v[240:243], v[52:55]
    ds_read_b128 v[120:123], v13 offset:32768
    v_mfma_f32_16x16x32_bf16 v[60:63], v[132:135], v[244:247], v[60:63]
    ds_read_b128 v[124:127], v13 offset:34816
    v_mfma_f32_16x16x32_bf16 v[68:71], v[132:135], v[112:115], v[68:71]
    ds_read_b64_tr_b16 v[148:149], v15 offset:36864
    v_mfma_f32_16x16x32_bf16 v[76:79], v[132:135], v[116:119], v[76:79]
    ds_read_b64_tr_b16 v[150:151], v15 offset:37376
    s_waitcnt lgkmcnt(10)
    v_mfma_f32_16x16x32_bf16 v[80:83], v[136:139], v[240:243], v[80:83]
    ds_read_b64_tr_b16 v[152:153], v14 offset:45056
    v_mfma_f32_16x16x32_bf16 v[88:91], v[136:139], v[244:247], v[88:91]
    ds_read_b64_tr_b16 v[154:155], v14 offset:45568
    v_mfma_f32_16x16x32_bf16 v[96:99], v[136:139], v[112:115], v[96:99]
    ds_read_b64_tr_b16 v[156:157], v15 offset:45056
    v_mfma_f32_16x16x32_bf16 v[104:107], v[136:139], v[116:119], v[104:107]
    ds_read_b64_tr_b16 v[158:159], v15 offset:45568
    s_waitcnt lgkmcnt(7)
    v_mfma_f32_16x16x32_bf16 v[64:67], v[144:147], v[120:123], v[64:67]
    s_waitcnt lgkmcnt(6)
    v_mfma_f32_16x16x32_bf16 v[72:75], v[144:147], v[124:127], v[72:75]
    s_waitcnt lgkmcnt(4)
    v_mfma_f32_16x16x32_bf16 v[68:71], v[148:151], v[120:123], v[68:71]
    v_mfma_f32_16x16x32_bf16 v[76:79], v[148:151], v[124:127], v[76:79]
    v_mfma_f32_16x16x32_bf16 v[48:51], v[144:147], v[248:251], v[48:51]
    v_mfma_f32_16x16x32_bf16 v[56:59], v[144:147], v[252:255], v[56:59]
    v_mfma_f32_16x16x32_bf16 v[52:55], v[148:151], v[248:251], v[52:55]
    v_mfma_f32_16x16x32_bf16 v[60:63], v[148:151], v[252:255], v[60:63]
    s_waitcnt lgkmcnt(0)
    s_barrier
    s_setprio 1
    v_mfma_f32_16x16x32_bf16 v[84:87], v[140:143], v[240:243], v[84:87]
    v_mfma_f32_16x16x32_bf16 v[92:95], v[140:143], v[244:247], v[92:95]
    v_cvt_pk_bf16_f32 v128, v64, v65
    v_cvt_pk_bf16_f32 v129, v66, v67
    v_mfma_f32_16x16x32_bf16 v[100:103], v[140:143], v[112:115], v[100:103]
    v_cvt_pk_bf16_f32 v130, v72, v73
    v_cvt_pk_bf16_f32 v131, v74, v75
    v_mfma_f32_16x16x32_bf16 v[108:111], v[140:143], v[116:119], v[108:111]
    v_cvt_pk_bf16_f32 v132, v68, v69
    v_cvt_pk_bf16_f32 v133, v70, v71
    v_mfma_f32_16x16x32_bf16 v[80:83], v[152:155], v[248:251], v[80:83]
    v_cvt_pk_bf16_f32 v134, v76, v77
    v_cvt_pk_bf16_f32 v135, v78, v79
    v_mfma_f32_16x16x32_bf16 v[88:91], v[152:155], v[252:255], v[88:91]
    v_permlane16_swap_b32 v128, v130
    v_permlane16_swap_b32 v129, v131
    v_mfma_f32_16x16x32_bf16 v[96:99], v[152:155], v[120:123], v[96:99]
    v_permlane16_swap_b32 v132, v134
    v_permlane16_swap_b32 v133, v135
    v_mfma_f32_16x16x32_bf16 v[104:107], v[152:155], v[124:127], v[104:107]
    v_cvt_pk_bf16_f32 v144, v48, v49
    v_cvt_pk_bf16_f32 v145, v50, v51
    v_mfma_f32_32x32x16_bf16 v[64:79], v[24:27], v[128:131], 0
    v_cvt_pk_bf16_f32 v146, v56, v57
    v_cvt_pk_bf16_f32 v147, v58, v59
    v_mfma_f32_32x32x16_bf16 v[64:79], v[28:31], v[132:135], v[64:79]
    v_cvt_pk_bf16_f32 v148, v52, v53
    v_cvt_pk_bf16_f32 v149, v54, v55
    v_mfma_f32_16x16x32_bf16 v[84:87], v[156:159], v[248:251], v[84:87]
    v_cvt_pk_bf16_f32 v150, v60, v61
    v_cvt_pk_bf16_f32 v151, v62, v63
    v_mfma_f32_16x16x32_bf16 v[92:95], v[156:159], v[252:255], v[92:95]
    v_permlane16_swap_b32 v144, v146
    v_permlane16_swap_b32 v145, v147
    v_mfma_f32_16x16x32_bf16 v[100:103], v[156:159], v[120:123], v[100:103]
    v_permlane16_swap_b32 v148, v150
    v_permlane16_swap_b32 v149, v151
    v_mfma_f32_16x16x32_bf16 v[108:111], v[156:159], v[124:127], v[108:111]
    v_mfma_f32_32x32x16_bf16 v[48:63], v[24:27], v[144:147], 0
    v_mfma_f32_32x32x16_bf16 v[48:63], v[28:31], v[148:151], v[48:63]
    v_max3_f32 v10, v64, v65, v66
    v_max3_f32 v12, -v64, -v65, -v66
    v_max3_f32 v10, v10, v67, v68
    v_max3_f32 v12, v12, -v67, -v68
    v_max3_f32 v10, v10, v69, v70
    v_cvt_pk_bf16_f32 v80, v80, v81
    v_max3_f32 v12, v12, -v69, -v70
    v_cvt_pk_bf16_f32 v81, v82, v83
    v_max3_f32 v10, v10, v71, v72
    v_cvt_pk_bf16_f32 v82, v84, v85
    v_max3_f32 v12, v12, -v71, -v72
    v_cvt_pk_bf16_f32 v83, v86, v87
    v_max3_f32 v10, v10, v73, v74
    v_cvt_pk_bf16_f32 v84, v88, v89
    v_max3_f32 v12, v12, -v73, -v74
    v_cvt_pk_bf16_f32 v85, v90, v91
    v_max3_f32 v10, v10, v75, v76
    ds_write2st64_b64 v20, v[80:81], v[84:85] offset0:0 offset1:2
    v_max3_f32 v12, v12, -v75, -v76
    v_cvt_pk_bf16_f32 v86, v92, v93
    v_max3_f32 v10, v10, v77, v78
    v_cvt_pk_bf16_f32 v87, v94, v95
    v_max3_f32 v12, v12, -v77, -v78
    ds_write2st64_b64 v21, v[82:83], v[86:87] offset0:0 offset1:2
    v_max_f32_e64 v10, v10, v79
    v_cvt_pk_bf16_f32 v88, v96, v97
    v_max_f32_e64 v12, v12, -v79
    v_cvt_pk_bf16_f32 v89, v98, v99
    s_nop 0
    v_permlane32_swap_b32 v10, v12
    v_cvt_pk_bf16_f32 v90, v100, v101
    v_max_f32_e64 v10, v10, v12
    v_cvt_pk_bf16_f32 v91, v102, v103
    v_mul_f32_e64 v12, s42, v10
    v_cvt_pk_bf16_f32 v92, v104, v105
    v_mul_f32_e64 v10, s42, v10
    v_cvt_pk_bf16_f32 v93, v106, v107
    s_nop 0
    v_permlane32_swap_b32 v10, v12
    ds_write2st64_b64 v22, v[88:89], v[92:93] offset0:0 offset1:2
    v_pk_fma_f32 v[112:113], v[64:65], s[42:43], v[12:13] op_sel_hi:[1,1,0]
    v_cvt_pk_bf16_f32 v94, v108, v109
    v_pk_fma_f32 v[64:65], v[64:65], s[40:41], v[10:11] op_sel_hi:[1,1,0]
    v_cvt_pk_bf16_f32 v95, v110, v111
    v_pk_fma_f32 v[114:115], v[66:67], s[42:43], v[12:13] op_sel_hi:[1,1,0]
    ds_write2st64_b64 v23, v[90:91], v[94:95] offset0:0 offset1:2
    v_pk_fma_f32 v[66:67], v[66:67], s[40:41], v[10:11] op_sel_hi:[1,1,0]
    v_pk_fma_f32 v[116:117], v[68:69], s[42:43], v[12:13] op_sel_hi:[1,1,0]
    v_pk_fma_f32 v[68:69], v[68:69], s[40:41], v[10:11] op_sel_hi:[1,1,0]
    v_pk_fma_f32 v[118:119], v[70:71], s[42:43], v[12:13] op_sel_hi:[1,1,0]
    v_pk_fma_f32 v[70:71], v[70:71], s[40:41], v[10:11] op_sel_hi:[1,1,0]
    v_pk_fma_f32 v[120:121], v[72:73], s[42:43], v[12:13] op_sel_hi:[1,1,0]
    v_pk_fma_f32 v[72:73], v[72:73], s[40:41], v[10:11] op_sel_hi:[1,1,0]
    v_pk_fma_f32 v[122:123], v[74:75], s[42:43], v[12:13] op_sel_hi:[1,1,0]
    v_pk_fma_f32 v[74:75], v[74:75], s[40:41], v[10:11] op_sel_hi:[1,1,0]
    v_pk_fma_f32 v[124:125], v[76:77], s[42:43], v[12:13] op_sel_hi:[1,1,0]
    v_pk_fma_f32 v[76:77], v[76:77], s[40:41], v[10:11] op_sel_hi:[1,1,0]
    v_pk_fma_f32 v[126:127], v[78:79], s[42:43], v[12:13] op_sel_hi:[1,1,0]
    v_pk_fma_f32 v[78:79], v[78:79], s[40:41], v[10:11] op_sel_hi:[1,1,0]
    v_exp_f32 v112, v112
    v_exp_f32 v113, v113
    v_exp_f32 v114, v114
    v_exp_f32 v115, v115
    v_max3_f32 v14, v48, v49, v50
    v_exp_f32_e64 v64, v64
    v_max3_f32 v2, -v48, -v49, -v50
    v_exp_f32_e64 v65, v65
    v_max3_f32 v14, v14, v51, v52
    v_exp_f32_e64 v66, v66
    v_max3_f32 v2, v2, -v51, -v52
    v_exp_f32_e64 v67, v67
    v_max3_f32 v14, v14, v53, v54
    v_exp_f32_e64 v116, v116
    v_max3_f32 v2, v2, -v53, -v54
    v_exp_f32_e64 v117, v117
    v_max3_f32 v14, v14, v55, v56
    v_exp_f32_e64 v118, v118
    v_max3_f32 v2, v2, -v55, -v56
    v_exp_f32_e64 v119, v119
    v_max3_f32 v14, v14, v57, v58
    v_exp_f32_e64 v68, v68
    v_max3_f32 v2, v2, -v57, -v58
    v_exp_f32_e64 v69, v69
    v_max3_f32 v14, v14, v59, v60
    v_exp_f32_e64 v70, v70
    v_max3_f32 v2, v2, -v59, -v60
    v_exp_f32_e64 v71, v71
    v_max3_f32 v14, v14, v61, v62
    v_pk_add_f32 v[128:129], v[112:113], v[114:115]
    v_max3_f32 v2, v2, -v61, -v62
    v_pk_add_f32 v[136:137], v[64:65], v[66:67]
    v_max_f32 v14, v14, v63
    v_exp_f32 v120, v120
    v_max_f32_e64 v2, v2, -v63
    v_exp_f32 v121, v121
    s_nop 0
    v_permlane32_swap_b32 v14, v2
    v_exp_f32 v122, v122
    v_max_f32 v14, v14, v2
    v_exp_f32 v123, v123
    v_mul_f32 v2, s42, v14
    v_exp_f32 v72, v72
    v_mul_f32 v14, s42, v14
    v_exp_f32 v73, v73
    s_nop 0
    v_permlane32_swap_b32 v14, v2
    v_exp_f32_e64 v74, v74
    v_pk_fma_f32 v[96:97], v[48:49], s[42:43], v[2:3] op_sel_hi:[1,1,0]
    v_exp_f32_e64 v75, v75
    v_pk_fma_f32 v[48:49], v[48:49], s[40:41], v[14:15] op_sel_hi:[1,1,0]
    v_pk_add_f32 v[130:131], v[116:117], v[118:119]
    v_pk_fma_f32 v[98:99], v[50:51], s[42:43], v[2:3] op_sel_hi:[1,1,0]
    v_pk_add_f32 v[138:139], v[68:69], v[70:71]
    v_pk_fma_f32 v[50:51], v[50:51], s[40:41], v[14:15] op_sel_hi:[1,1,0]
    v_exp_f32_e64 v124, v124
    v_pk_fma_f32 v[100:101], v[52:53], s[42:43], v[2:3] op_sel_hi:[1,1,0]
    v_exp_f32_e64 v125, v125
    v_pk_fma_f32 v[52:53], v[52:53], s[40:41], v[14:15] op_sel_hi:[1,1,0]
    v_exp_f32_e64 v126, v126
    v_pk_fma_f32 v[102:103], v[54:55], s[42:43], v[2:3] op_sel_hi:[1,1,0]
    v_exp_f32_e64 v127, v127
    v_pk_fma_f32 v[54:55], v[54:55], s[40:41], v[14:15] op_sel_hi:[1,1,0]
    v_exp_f32_e64 v76, v76
    v_pk_fma_f32 v[104:105], v[56:57], s[42:43], v[2:3] op_sel_hi:[1,1,0]
    v_exp_f32_e64 v77, v77
    v_pk_fma_f32 v[56:57], v[56:57], s[40:41], v[14:15] op_sel_hi:[1,1,0]
    v_exp_f32_e64 v78, v78
    v_pk_fma_f32 v[106:107], v[58:59], s[42:43], v[2:3] op_sel_hi:[1,1,0]
    v_exp_f32_e64 v79, v79
    v_pk_fma_f32 v[58:59], v[58:59], s[40:41], v[14:15] op_sel_hi:[1,1,0]
    v_pk_add_f32 v[132:133], v[120:121], v[122:123]
    v_pk_fma_f32 v[108:109], v[60:61], s[42:43], v[2:3] op_sel_hi:[1,1,0]
    v_pk_add_f32 v[140:141], v[72:73], v[74:75]
    v_pk_fma_f32 v[60:61], v[60:61], s[40:41], v[14:15] op_sel_hi:[1,1,0]
    v_pk_add_f32 v[128:129], v[128:129], v[130:131]
    v_pk_fma_f32 v[110:111], v[62:63], s[42:43], v[2:3] op_sel_hi:[1,1,0]
    v_pk_add_f32 v[136:137], v[136:137], v[138:139]
    v_pk_fma_f32 v[62:63], v[62:63], s[40:41], v[14:15] op_sel_hi:[1,1,0]
    v_pk_add_f32 v[134:135], v[124:125], v[126:127]
    v_exp_f32_e64 v96, v96
    v_pk_add_f32 v[142:143], v[76:77], v[78:79]
    v_exp_f32_e64 v97, v97
    v_pk_add_f32 v[132:133], v[132:133], v[134:135]
    v_exp_f32_e64 v98, v98
    v_pk_add_f32 v[140:141], v[140:141], v[142:143]
    v_exp_f32_e64 v99, v99
    v_pk_add_f32 v[128:129], v[128:129], v[132:133]
    v_exp_f32_e64 v48, v48
    v_pk_add_f32 v[136:137], v[136:137], v[140:141]
    v_exp_f32 v49, v49
    v_add_f32 v10, v136, v137
    v_exp_f32 v50, v50
    v_add_f32 v12, v128, v129
    v_exp_f32 v51, v51
    s_nop 0
    v_permlane32_swap_b32 v10, v12
    v_exp_f32 v100, v100
    v_add_f32 v10, v10, v12
    v_exp_f32 v101, v101
    v_rcp_f32 v12, v10
    v_exp_f32 v102, v102
    v_rcp_f32 v10, v10
    v_exp_f32 v103, v103
    s_nop 0
    v_permlane32_swap_b32 v10, v12
    v_exp_f32_e64 v52, v52
    v_pk_mul_f32 v[64:65], v[64:65], v[10:11] op_sel_hi:[1,0]
    v_exp_f32_e64 v53, v53
    v_pk_mul_f32 v[112:113], v[112:113], v[12:13] op_sel_hi:[1,0]
    v_exp_f32_e64 v54, v54
    v_pk_mul_f32 v[66:67], v[66:67], v[10:11] op_sel_hi:[1,0]
    v_exp_f32_e64 v55, v55
    v_pk_mul_f32 v[114:115], v[114:115], v[12:13] op_sel_hi:[1,0]
    v_pk_add_f32 v[144:145], v[96:97], v[98:99]
    v_cvt_pk_bf16_f32 v128, v64, v65
    v_pk_add_f32 v[152:153], v[48:49], v[50:51]
    v_cvt_pk_bf16_f32 v136, v112, v113
    v_exp_f32_e64 v104, v104
    v_pk_mul_f32 v[68:69], v[68:69], v[10:11] op_sel_hi:[1,0]
    v_exp_f32_e64 v105, v105
    v_pk_mul_f32 v[116:117], v[116:117], v[12:13] op_sel_hi:[1,0]
    v_exp_f32_e64 v106, v106
    v_cvt_pk_bf16_f32 v129, v66, v67
    v_exp_f32_e64 v107, v107
    v_cvt_pk_bf16_f32 v137, v114, v115
    v_exp_f32 v56, v56
    ds_write2st64_b64 v40, v[128:129], v[136:137] offset0:0 offset1:16
    v_exp_f32 v57, v57
    v_pk_mul_f32 v[70:71], v[70:71], v[10:11] op_sel_hi:[1,0]
    v_exp_f32_e64 v58, v58
    v_pk_mul_f32 v[118:119], v[118:119], v[12:13] op_sel_hi:[1,0]
    v_exp_f32_e64 v59, v59
    v_cvt_pk_bf16_f32 v130, v68, v69
    v_pk_add_f32 v[146:147], v[100:101], v[102:103]
    v_cvt_pk_bf16_f32 v138, v116, v117
    v_pk_add_f32 v[154:155], v[52:53], v[54:55]
    v_pk_mul_f32 v[72:73], v[72:73], v[10:11] op_sel_hi:[1,0]
    v_exp_f32_e64 v108, v108
    v_pk_mul_f32 v[120:121], v[120:121], v[12:13] op_sel_hi:[1,0]
    v_exp_f32_e64 v109, v109
    v_cvt_pk_bf16_f32 v131, v70, v71
    v_exp_f32_e64 v110, v110
    v_cvt_pk_bf16_f32 v139, v118, v119
    v_exp_f32 v111, v111
    ds_write2st64_b64 v41, v[130:131], v[138:139] offset0:0 offset1:16
    v_exp_f32 v60, v60
    v_pk_mul_f32 v[74:75], v[74:75], v[10:11] op_sel_hi:[1,0]
    v_exp_f32_e64 v61, v61
    v_pk_mul_f32 v[122:123], v[122:123], v[12:13] op_sel_hi:[1,0]
    v_exp_f32_e64 v62, v62
    v_cvt_pk_bf16_f32 v132, v72, v73
    v_exp_f32_e64 v63, v63
    v_cvt_pk_bf16_f32 v140, v120, v121
    v_pk_add_f32 v[148:149], v[104:105], v[106:107]
    v_pk_mul_f32 v[76:77], v[76:77], v[10:11] op_sel_hi:[1,0]
    v_pk_add_f32 v[156:157], v[56:57], v[58:59]
    v_pk_mul_f32 v[124:125], v[124:125], v[12:13] op_sel_hi:[1,0]
    v_pk_add_f32 v[144:145], v[144:145], v[146:147]
    v_cvt_pk_bf16_f32 v133, v74, v75
    v_pk_add_f32 v[152:153], v[152:153], v[154:155]
    v_cvt_pk_bf16_f32 v141, v122, v123
    v_pk_add_f32 v[150:151], v[108:109], v[110:111]
    ds_write2st64_b64 v42, v[132:133], v[140:141] offset0:0 offset1:16
    v_pk_add_f32 v[158:159], v[60:61], v[62:63]
    v_pk_mul_f32 v[78:79], v[78:79], v[10:11] op_sel_hi:[1,0]
    v_pk_add_f32 v[148:149], v[148:149], v[150:151]
    v_pk_mul_f32 v[126:127], v[126:127], v[12:13] op_sel_hi:[1,0]
    v_pk_add_f32 v[156:157], v[156:157], v[158:159]
    v_cvt_pk_bf16_f32 v134, v76, v77
    v_pk_add_f32 v[144:145], v[144:145], v[148:149]
    v_cvt_pk_bf16_f32 v142, v124, v125
    v_pk_add_f32 v[152:153], v[152:153], v[156:157]
    v_cvt_pk_bf16_f32 v135, v78, v79
    v_add_f32_e64 v14, v152, v153
    v_cvt_pk_bf16_f32 v143, v126, v127
    v_add_f32 v2, v144, v145
    ds_write2st64_b64 v43, v[134:135], v[142:143] offset0:0 offset1:16
    s_nop 0
    v_permlane32_swap_b32 v14, v2
    v_add_f32 v14, v14, v2
    v_rcp_f32 v2, v14
    v_rcp_f32 v14, v14
    s_nop 1
    v_permlane32_swap_b32 v14, v2
    v_pk_mul_f32 v[48:49], v[48:49], v[14:15] op_sel_hi:[1,0]
    v_pk_mul_f32 v[96:97], v[96:97], v[2:3] op_sel_hi:[1,0]
    v_pk_mul_f32 v[50:51], v[50:51], v[14:15] op_sel_hi:[1,0]
    v_pk_mul_f32 v[98:99], v[98:99], v[2:3] op_sel_hi:[1,0]
    v_cvt_pk_bf16_f32 v144, v48, v49
    v_cvt_pk_bf16_f32 v152, v96, v97
    v_pk_mul_f32 v[52:53], v[52:53], v[14:15] op_sel_hi:[1,0]
    v_pk_mul_f32 v[100:101], v[100:101], v[2:3] op_sel_hi:[1,0]
    v_cvt_pk_bf16_f32 v145, v50, v51
    v_cvt_pk_bf16_f32 v153, v98, v99
    ds_write2st64_b64 v4, v[144:145], v[152:153] offset0:0 offset1:16
    v_pk_mul_f32 v[54:55], v[54:55], v[14:15] op_sel_hi:[1,0]
    v_pk_mul_f32 v[102:103], v[102:103], v[2:3] op_sel_hi:[1,0]
    v_cvt_pk_bf16_f32 v146, v52, v53
    v_cvt_pk_bf16_f32 v154, v100, v101
    v_pk_mul_f32 v[56:57], v[56:57], v[14:15] op_sel_hi:[1,0]
    v_pk_mul_f32 v[104:105], v[104:105], v[2:3] op_sel_hi:[1,0]
    v_cvt_pk_bf16_f32 v147, v54, v55
    v_cvt_pk_bf16_f32 v155, v102, v103
    ds_write2st64_b64 v5, v[146:147], v[154:155] offset0:0 offset1:16
    v_pk_mul_f32 v[58:59], v[58:59], v[14:15] op_sel_hi:[1,0]
    v_pk_mul_f32 v[106:107], v[106:107], v[2:3] op_sel_hi:[1,0]
    v_cvt_pk_bf16_f32 v148, v56, v57
    v_cvt_pk_bf16_f32 v156, v104, v105
    v_pk_mul_f32 v[60:61], v[60:61], v[14:15] op_sel_hi:[1,0]
    v_pk_mul_f32 v[108:109], v[108:109], v[2:3] op_sel_hi:[1,0]
    v_cvt_pk_bf16_f32 v149, v58, v59
    v_cvt_pk_bf16_f32 v157, v106, v107
    ds_write2st64_b64 v6, v[148:149], v[156:157] offset0:0 offset1:16
    v_pk_mul_f32 v[62:63], v[62:63], v[14:15] op_sel_hi:[1,0]
    v_pk_mul_f32 v[110:111], v[110:111], v[2:3] op_sel_hi:[1,0]
    v_cvt_pk_bf16_f32 v150, v60, v61
    v_cvt_pk_bf16_f32 v158, v108, v109
    v_cvt_pk_bf16_f32 v151, v62, v63
    v_cvt_pk_bf16_f32 v159, v110, v111
    ds_write2st64_b64 v7, v[150:151], v[158:159] offset0:0 offset1:16
    s_waitcnt lgkmcnt(0)
    s_barrier
    ds_read_b64_tr_b16 v[48:49], v32 offset:0
    ds_read_b64_tr_b16 v[50:51], v33 offset:0
    ds_read_b64_tr_b16 v[80:81], v34 offset:0
    ds_read_b64_tr_b16 v[82:83], v35 offset:0
    ds_read_b64_tr_b16 v[52:53], v32 offset:1024
    ds_read_b64_tr_b16 v[54:55], v33 offset:1024
    ds_read_b64_tr_b16 v[84:85], v34 offset:1024
    ds_read_b64_tr_b16 v[86:87], v35 offset:1024
    ds_read_b64_tr_b16 v[56:57], v32 offset:2048
    ds_read_b64_tr_b16 v[58:59], v33 offset:2048
    ds_read_b64_tr_b16 v[88:89], v34 offset:2048
    ds_read_b64_tr_b16 v[90:91], v35 offset:2048
    ds_read_b64_tr_b16 v[60:61], v32 offset:3072
    ds_read_b64_tr_b16 v[62:63], v33 offset:3072
    ds_read_b64_tr_b16 v[92:93], v34 offset:3072
    ds_read_b64_tr_b16 v[94:95], v35 offset:3072
    v_mov_b32 v115, s44
    v_mov_b32 v119, s44
    v_mov_b32 v123, s44
    v_mov_b32 v127, s44
    v_mov_b32 v118, 0
    v_mov_b32 v122, 0
    v_mov_b32 v126, 0
    s_waitcnt vmcnt(0)
    v_xor_b32 v47, s44, v47
    s_mov_b32 s45, 0
L_va:
    v_cmp_eq_u32 vcc, 0, v47
    s_nop 0
    s_bcnt1_i32_b32 s1, vcc_lo
    v_cmp_eq_u32 vcc, 1, v47
    s_add_u32 s1, s1, 1
    s_bcnt1_i32_b32 s0, vcc_lo
    s_max_u32 s1, s1, s0
    s_cmp_gt_u32 s1, 16
    s_cbranch_scc1 L_va_d
    s_add_u32 s45, s45, 1
    s_cmp_ge_u32 s45, 200000
    s_cbranch_scc1 L_va_d
    s_mov_b32 s46, 458752
    v_lshlrev_b32 v8, 2, v0
    v_mov_b32 v47, 0
    s_mov_b32 exec_hi, 0
    buffer_atomic_or v47, v8, s[28:31], s46 offen sc0
    s_mov_b32 exec_hi, -1
    s_waitcnt vmcnt(0)
    v_xor_b32 v47, s44, v47
    s_branch L_va
L_va_d:
    s_lshl_b32 s1, s2, 11
    s_cmp_gt_u32 s0, 16
    s_cselect_b32 s0, 0x2000, 0
    s_and_b32 s1, s1, 0x2000
    s_xor_b32 s0, s0, s1
    s_xor_b32 s57, s57, s0
    s_xor_b32 s58, s58, s0
    s_xor_b32 s16, s16, s0
    s_xor_b32 s18, s18, s0
    s_xor_b32 s17, s17, s0
    s_xor_b32 s20, s20, s0
    s_xor_b32 s22, s22, s0
    s_xor_b32 s24, s24, s0
    v_lshlrev_b32 v13, 7, v0
    v_mov_b32 v14, v16
    v_xor_b32 v15, 32, v14
    v_xor_b32_e64 v16, 64, v14
    v_xor_b32 v17, 96, v14
    s_waitcnt lgkmcnt(12)
    v_mfma_f32_32x32x16_bf16 v[128:143], v[48:51], v[80:83], 0
    ds_read_b64_tr_b16 v[64:65], v32 offset:4096
    ds_read_b64_tr_b16 v[66:67], v33 offset:4096
    ds_read_b64_tr_b16 v[96:97], v34 offset:4096
    ds_read_b64_tr_b16 v[98:99], v35 offset:4096
    s_waitcnt lgkmcnt(12)
    v_mfma_f32_32x32x16_bf16 v[128:143], v[52:55], v[84:87], v[128:143]
L_pad5:
    s_cbranch_execz L_ret
    s_nop 0
    ds_read_b64_tr_b16 v[68:69], v32 offset:5120
    ds_read_b64_tr_b16 v[70:71], v33 offset:5120
    ds_read_b64_tr_b16 v[100:101], v34 offset:5120
    ds_read_b64_tr_b16 v[102:103], v35 offset:5120
    s_waitcnt lgkmcnt(12)
    v_mfma_f32_32x32x16_bf16 v[128:143], v[56:59], v[88:91], v[128:143]
    ds_read_b64_tr_b16 v[72:73], v32 offset:6144
    ds_read_b64_tr_b16 v[74:75], v33 offset:6144
    ds_read_b64_tr_b16 v[104:105], v34 offset:6144
    ds_read_b64_tr_b16 v[106:107], v35 offset:6144
    s_waitcnt lgkmcnt(12)
    v_mfma_f32_32x32x16_bf16 v[128:143], v[60:63], v[92:95], v[128:143]
    ds_read_b64_tr_b16 v[76:77], v32 offset:7168
    ds_read_b64_tr_b16 v[78:79], v33 offset:7168
    ds_read_b64_tr_b16 v[108:109], v34 offset:7168
    ds_read_b64_tr_b16 v[110:111], v35 offset:7168
    s_waitcnt lgkmcnt(12)
    v_mfma_f32_32x32x16_bf16 v[128:143], v[64:67], v[96:99], v[128:143]
    s_waitcnt lgkmcnt(8)
    v_mfma_f32_32x32x16_bf16 v[128:143], v[68:71], v[100:103], v[128:143]
    s_waitcnt lgkmcnt(4)
    v_mfma_f32_32x32x16_bf16 v[128:143], v[72:75], v[104:107], v[128:143]
    s_waitcnt lgkmcnt(0)
    v_mfma_f32_32x32x16_bf16 v[128:143], v[76:79], v[108:111], v[128:143]
    s_mov_b64 exec, 15
    buffer_atomic_swap v115, v13, s[28:31], s58 offen
    s_mov_b64 exec, -1
    v_mfma_f32_16x16x32_bf16 v[144:147], v[36:39], v[48:51], 0
    ds_read_b64_tr_b16 v[80:81], v14 offset:0
    ds_read_b64_tr_b16 v[82:83], v14 offset:512
    v_mfma_f32_16x16x32_bf16 v[144:147], v[36:39], v[52:55], v[144:147]
    ds_read_b64_tr_b16 v[84:85], v15 offset:0
    ds_read_b64_tr_b16 v[86:87], v15 offset:512
    v_mfma_f32_16x16x32_bf16 v[144:147], v[36:39], v[56:59], v[144:147]
    ds_read_b64_tr_b16 v[88:89], v16 offset:0
    ds_read_b64_tr_b16 v[90:91], v16 offset:512
    v_mfma_f32_16x16x32_bf16 v[144:147], v[36:39], v[60:63], v[144:147]
    ds_read_b64_tr_b16 v[92:93], v17 offset:0
    ds_read_b64_tr_b16 v[94:95], v17 offset:512
    v_cvt_pk_bf16_f32 v124, v140, v141
    v_cvt_pk_bf16_f32 v125, v142, v143
    buffer_store_dwordx4 v[124:127], v44, s[28:31], s57 offen offset:768 sc1
    v_mfma_f32_16x16x32_bf16 v[144:147], v[36:39], v[64:67], v[144:147]
    ds_read_b64_tr_b16 v[96:97], v14 offset:4096
    ds_read_b64_tr_b16 v[98:99], v14 offset:4608
    v_cvt_pk_bf16_f32 v120, v136, v137
    v_cvt_pk_bf16_f32 v121, v138, v139
    buffer_store_dwordx4 v[120:123], v44, s[28:31], s57 offen offset:512 sc1
    v_mfma_f32_16x16x32_bf16 v[144:147], v[36:39], v[68:71], v[144:147]
    ds_read_b64_tr_b16 v[100:101], v15 offset:4096
    ds_read_b64_tr_b16 v[102:103], v15 offset:4608
    v_cvt_pk_bf16_f32 v116, v132, v133
    v_cvt_pk_bf16_f32 v117, v134, v135
    buffer_store_dwordx4 v[116:119], v44, s[28:31], s57 offen offset:256 sc1
    v_mfma_f32_16x16x32_bf16 v[144:147], v[36:39], v[72:75], v[144:147]
    v_mfma_f32_16x16x32_bf16 v[144:147], v[36:39], v[76:79], v[144:147]
    ds_read_b64_tr_b16 v[104:105], v16 offset:4096
    ds_read_b64_tr_b16 v[106:107], v16 offset:4608
    v_cvt_pk_bf16_f32 v112, v128, v129
    v_cvt_pk_bf16_f32 v113, v130, v131
    s_nop 0
    s_nop 3
    v_cvt_pk_bf16_f32 v114, v144, v144
    buffer_store_dwordx4 v[112:115], v44, s[28:31], s57 offen offset:0 sc1
    s_waitcnt lgkmcnt(12)
    v_mfma_f32_16x16x32_bf16 v[48:51], v[80:83], v[160:163], 0
    ds_read_b64_tr_b16 v[108:109], v17 offset:4096
    v_mfma_f32_16x16x32_bf16 v[64:67], v[80:83], v[164:167], 0
    ds_read_b64_tr_b16 v[110:111], v17 offset:4608
    s_waitcnt lgkmcnt(12)
    v_mfma_f32_16x16x32_bf16 v[52:55], v[84:87], v[160:163], 0
    v_and_b32 v1, 1, v0
    ds_read_b64_tr_b16 v[80:81], v14 offset:8192
    v_mfma_f32_16x16x32_bf16 v[68:71], v[84:87], v[164:167], 0
    ds_read_b64_tr_b16 v[82:83], v14 offset:8704
    s_waitcnt lgkmcnt(12)
    v_mfma_f32_16x16x32_bf16 v[56:59], v[88:91], v[160:163], 0
    v_lshlrev_b32 v1, 4, v1
    ds_read_b64_tr_b16 v[84:85], v15 offset:8192
    v_mfma_f32_16x16x32_bf16 v[72:75], v[88:91], v[164:167], 0
    ds_read_b64_tr_b16 v[86:87], v15 offset:8704
    s_waitcnt lgkmcnt(12)
    v_mfma_f32_16x16x32_bf16 v[60:63], v[92:95], v[160:163], 0
    v_mov_b32 v2, 0x3f80
    ds_read_b64_tr_b16 v[88:89], v16 offset:8192
    v_mfma_f32_16x16x32_bf16 v[76:79], v[92:95], v[164:167], 0
    ds_read_b64_tr_b16 v[90:91], v16 offset:8704
    s_waitcnt lgkmcnt(12)
    v_mfma_f32_16x16x32_bf16 v[48:51], v[96:99], v[168:171], v[48:51]
    v_lshlrev_b32 v1, v1, v2
    ds_read_b64_tr_b16 v[92:93], v17 offset:8192
    v_mfma_f32_16x16x32_bf16 v[64:67], v[96:99], v[172:175], v[64:67]
    ds_read_b64_tr_b16 v[94:95], v17 offset:8704
    s_waitcnt lgkmcnt(12)
    v_mfma_f32_16x16x32_bf16 v[52:55], v[100:103], v[168:171], v[52:55]
    s_nop 0
    v_bfe_u32 v2, v0, 1, 2
    ds_read_b64_tr_b16 v[96:97], v14 offset:12288
    v_mfma_f32_16x16x32_bf16 v[68:71], v[100:103], v[172:175], v[68:71]
    ds_read_b64_tr_b16 v[98:99], v14 offset:12800
    s_waitcnt lgkmcnt(12)
    v_mfma_f32_16x16x32_bf16 v[56:59], v[104:107], v[168:171], v[56:59]
    v_mov_b32 v135, s44
    ds_read_b64_tr_b16 v[100:101], v15 offset:12288
    v_mfma_f32_16x16x32_bf16 v[72:75], v[104:107], v[172:175], v[72:75]
    ds_read_b64_tr_b16 v[102:103], v15 offset:12800
    s_waitcnt lgkmcnt(12)
    v_mfma_f32_16x16x32_bf16 v[60:63], v[108:111], v[168:171], v[60:63]
    v_cmp_eq_u32 vcc, 0, v2
    s_mov_b64 exec, 0xffff
    v_mov_b32 v12, 0
    buffer_atomic_or v12, v8, s[28:31], s16 offen sc0
    s_mov_b64 exec, -1
    ds_read_b64_tr_b16 v[104:105], v16 offset:12288
    v_mfma_f32_16x16x32_bf16 v[76:79], v[108:111], v[172:175], v[76:79]
    ds_read_b64_tr_b16 v[106:107], v16 offset:12800
    s_waitcnt lgkmcnt(12)
    v_mfma_f32_16x16x32_bf16 v[48:51], v[80:83], v[176:179], v[48:51]
    v_cndmask_b32 v36, 0, v1, vcc
    ds_read_b64_tr_b16 v[108:109], v17 offset:12288
    v_mfma_f32_16x16x32_bf16 v[64:67], v[80:83], v[180:183], v[64:67]
    ds_read_b64_tr_b16 v[110:111], v17 offset:12800
    s_waitcnt lgkmcnt(12)
    v_mfma_f32_16x16x32_bf16 v[52:55], v[84:87], v[176:179], v[52:55]
    v_cmp_eq_u32 vcc, 1, v2
    s_barrier
    ds_read_b64_tr_b16 v[80:81], v14 offset:32768
    v_mfma_f32_16x16x32_bf16 v[68:71], v[84:87], v[180:183], v[68:71]
    ds_read_b64_tr_b16 v[82:83], v14 offset:33280
    s_waitcnt lgkmcnt(12)
    v_mfma_f32_16x16x32_bf16 v[56:59], v[88:91], v[176:179], v[56:59]
    v_cndmask_b32 v37, 0, v1, vcc
    ds_read_b64_tr_b16 v[84:85], v15 offset:32768
    v_mfma_f32_16x16x32_bf16 v[72:75], v[88:91], v[180:183], v[72:75]
    ds_read_b64_tr_b16 v[86:87], v15 offset:33280
    s_waitcnt lgkmcnt(12)
    v_mfma_f32_16x16x32_bf16 v[60:63], v[92:95], v[176:179], v[60:63]
    v_cmp_eq_u32 vcc, 2, v2
    ds_read_b64_tr_b16 v[88:89], v16 offset:32768
    v_mfma_f32_16x16x32_bf16 v[76:79], v[92:95], v[180:183], v[76:79]
    ds_read_b64_tr_b16 v[90:91], v16 offset:33280
    s_waitcnt lgkmcnt(12)
    v_mfma_f32_16x16x32_bf16 v[48:51], v[96:99], v[184:187], v[48:51]
    v_cndmask_b32 v38, 0, v1, vcc
    ds_read_b64_tr_b16 v[92:93], v17 offset:32768
    v_mfma_f32_16x16x32_bf16 v[64:67], v[96:99], v[188:191], v[64:67]
    ds_read_b64_tr_b16 v[94:95], v17 offset:33280
    s_waitcnt lgkmcnt(12)
    v_mfma_f32_16x16x32_bf16 v[52:55], v[100:103], v[184:187], v[52:55]
    v_cmp_eq_u32 vcc, 3, v2
    ds_read_b64_tr_b16 v[96:97], v14 offset:36864
    v_mfma_f32_16x16x32_bf16 v[68:71], v[100:103], v[188:191], v[68:71]
    ds_read_b64_tr_b16 v[98:99], v14 offset:37376
    s_waitcnt lgkmcnt(12)
    v_mfma_f32_16x16x32_bf16 v[56:59], v[104:107], v[184:187], v[56:59]
    v_cndmask_b32 v39, 0, v1, vcc
    ds_read_b64_tr_b16 v[100:101], v15 offset:36864
    v_mfma_f32_16x16x32_bf16 v[72:75], v[104:107], v[188:191], v[72:75]
    ds_read_b64_tr_b16 v[102:103], v15 offset:37376
    s_waitcnt lgkmcnt(12)
    v_mfma_f32_16x16x32_bf16 v[60:63], v[108:111], v[184:187], v[60:63]
    v_mov_b32 v22, 0x3f803f80
    ds_read_b64_tr_b16 v[104:105], v16 offset:36864
    v_mfma_f32_16x16x32_bf16 v[76:79], v[108:111], v[188:191], v[76:79]
    ds_read_b64_tr_b16 v[106:107], v16 offset:37376
    s_waitcnt lgkmcnt(12)
    v_mfma_f32_16x16x32_bf16 v[48:51], v[80:83], v[192:195], v[48:51]
    v_mov_b32 v2, 0
    ds_read_b64_tr_b16 v[108:109], v17 offset:36864
    v_mfma_f32_16x16x32_bf16 v[64:67], v[80:83], v[196:199], v[64:67]
    ds_read_b64_tr_b16 v[110:111], v17 offset:37376
    s_waitcnt lgkmcnt(12)
    v_mfma_f32_16x16x32_bf16 v[52:55], v[84:87], v[192:195], v[52:55]
    v_and_b32 v3, 15, v0
    s_mov_b32 s45, 0
    s_mov_b64 exec, 0xffff
    s_branch L_f1_c
L_f1:
    v_mov_b32 v12, 0
    buffer_atomic_or v12, v8, s[28:31], s16 offen sc0
L_f1_c:
    s_waitcnt vmcnt(0)
    v_cmp_ne_u32 vcc, s44, v12
    s_add_u32 s45, s45, 1
    s_cmp_ge_u32 s45, 200000
    s_cbranch_scc1 L_f1_d
    s_cbranch_vccnz L_f1
L_f1_d:
    s_mov_b64 exec, -1
    buffer_load_dwordx4 v[136:139], v46, s[28:31], s18 offen offset:0 sc1
    buffer_load_dwordx4 v[140:143], v46, s[28:31], s18 offen offset:1024 sc1
    buffer_load_dwordx4 v[144:147], v46, s[28:31], s18 offen offset:2048 sc1
    buffer_load_dwordx4 v[148:151], v46, s[28:31], s18 offen offset:3072 sc1
    ds_read_b64_tr_b16 v[80:81], v14 offset:40960
    v_mfma_f32_16x16x32_bf16 v[68:71], v[84:87], v[196:199], v[68:71]
    ds_read_b64_tr_b16 v[82:83], v14 offset:41472
    s_waitcnt lgkmcnt(12)
    v_mfma_f32_16x16x32_bf16 v[56:59], v[88:91], v[192:195], v[56:59]
    v_lshrrev_b32 v4, 5, v0
    ds_read_b64_tr_b16 v[84:85], v15 offset:40960
    v_mfma_f32_16x16x32_bf16 v[72:75], v[88:91], v[196:199], v[72:75]
    ds_read_b64_tr_b16 v[86:87], v15 offset:41472
    s_waitcnt lgkmcnt(12)
    v_mfma_f32_16x16x32_bf16 v[60:63], v[92:95], v[192:195], v[60:63]
    v_bfe_u32 v5, v0, 4, 1
    ds_read_b64_tr_b16 v[88:89], v16 offset:40960
    v_mfma_f32_16x16x32_bf16 v[76:79], v[92:95], v[196:199], v[76:79]
    ds_read_b64_tr_b16 v[90:91], v16 offset:41472
    s_waitcnt lgkmcnt(12)
    v_mfma_f32_16x16x32_bf16 v[48:51], v[96:99], v[200:203], v[48:51]
    v_lshlrev_b32 v3, 4, v3
    ds_read_b64_tr_b16 v[92:93], v17 offset:40960
    v_mfma_f32_16x16x32_bf16 v[64:67], v[96:99], v[204:207], v[64:67]
    ds_read_b64_tr_b16 v[94:95], v17 offset:41472
    s_waitcnt lgkmcnt(12)
    v_mfma_f32_16x16x32_bf16 v[52:55], v[100:103], v[200:203], v[52:55]
    s_nop 0
    v_lshl_add_u32 v3, v4, 10, v3
    ds_read_b64_tr_b16 v[96:97], v14 offset:45056
    v_mfma_f32_16x16x32_bf16 v[68:71], v[100:103], v[204:207], v[68:71]
    ds_read_b64_tr_b16 v[98:99], v14 offset:45568
    s_waitcnt lgkmcnt(12)
    v_mfma_f32_16x16x32_bf16 v[56:59], v[104:107], v[200:203], v[56:59]
    s_nop 0
    v_lshl_add_u32 v3, v5, 3, v3
    ds_read_b64_tr_b16 v[100:101], v15 offset:45056
    v_mfma_f32_16x16x32_bf16 v[72:75], v[104:107], v[204:207], v[72:75]
    ds_read_b64_tr_b16 v[102:103], v15 offset:45568
    s_waitcnt lgkmcnt(12)
    v_mfma_f32_16x16x32_bf16 v[60:63], v[108:111], v[200:203], v[60:63]
    v_add_u32 v20, s56, v3
    ds_read_b64_tr_b16 v[104:105], v16 offset:45056
    v_mfma_f32_16x16x32_bf16 v[76:79], v[108:111], v[204:207], v[76:79]
    ds_read_b64_tr_b16 v[106:107], v16 offset:45568
    s_waitcnt lgkmcnt(12)
    v_mfma_f32_16x16x32_bf16 v[48:51], v[80:83], v[208:211], v[48:51]
    v_and_b32 v3, 3, v0
    ds_read_b64_tr_b16 v[108:109], v17 offset:45056
    v_mfma_f32_16x16x32_bf16 v[64:67], v[80:83], v[212:215], v[64:67]
    ds_read_b64_tr_b16 v[110:111], v17 offset:45568
    s_waitcnt lgkmcnt(12)
    v_mfma_f32_16x16x32_bf16 v[52:55], v[84:87], v[208:211], v[52:55]
    s_nop 0
    v_bfe_u32 v4, v0, 2, 1
    v_add_u32 v14, 81920, v14
    v_add_u32 v15, 81920, v15
    v_add_u32 v16, 81920, v16
    v_add_u32 v17, 81920, v17
    ds_read_b64_tr_b16 v[80:81], v14 offset:0
    v_mfma_f32_16x16x32_bf16 v[68:71], v[84:87], v[212:215], v[68:71]
    ds_read_b64_tr_b16 v[82:83], v14 offset:512
    s_waitcnt lgkmcnt(12)
    v_mfma_f32_16x16x32_bf16 v[56:59], v[88:91], v[208:211], v[56:59]
    v_and_b32 v5, 8, v0
    ds_read_b64_tr_b16 v[84:85], v15 offset:0
    v_mfma_f32_16x16x32_bf16 v[72:75], v[88:91], v[212:215], v[72:75]
    ds_read_b64_tr_b16 v[86:87], v15 offset:512
    s_waitcnt lgkmcnt(12)
    v_mfma_f32_16x16x32_bf16 v[60:63], v[92:95], v[208:211], v[60:63]
    v_lshrrev_b32 v6, 4, v0
    ds_read_b64_tr_b16 v[88:89], v16 offset:0
    v_mfma_f32_16x16x32_bf16 v[76:79], v[92:95], v[212:215], v[76:79]
    ds_read_b64_tr_b16 v[90:91], v16 offset:512
    s_waitcnt lgkmcnt(12)
    v_mfma_f32_16x16x32_bf16 v[48:51], v[96:99], v[216:219], v[48:51]
    s_nop 0
    v_lshl_add_u32 v3, v3, 1, v5
    ds_read_b64_tr_b16 v[92:93], v17 offset:0
    v_mfma_f32_16x16x32_bf16 v[64:67], v[96:99], v[220:223], v[64:67]
    ds_read_b64_tr_b16 v[94:95], v17 offset:512
    s_waitcnt lgkmcnt(12)
    v_mfma_f32_16x16x32_bf16 v[52:55], v[100:103], v[216:219], v[52:55]
    s_nop 0
    v_lshl_add_u32 v3, v4, 4, v3
    ds_read_b64_tr_b16 v[96:97], v14 offset:4096
    v_mfma_f32_16x16x32_bf16 v[68:71], v[100:103], v[220:223], v[68:71]
    ds_read_b64_tr_b16 v[98:99], v14 offset:4608
    s_waitcnt lgkmcnt(12)
    v_mfma_f32_16x16x32_bf16 v[56:59], v[104:107], v[216:219], v[56:59]
    s_nop 0
    v_lshl_add_u32 v3, v6, 10, v3
    ds_read_b64_tr_b16 v[100:101], v15 offset:4096
    v_mfma_f32_16x16x32_bf16 v[72:75], v[104:107], v[220:223], v[72:75]
    ds_read_b64_tr_b16 v[102:103], v15 offset:4608
    s_waitcnt lgkmcnt(12)
    v_mfma_f32_16x16x32_bf16 v[60:63], v[108:111], v[216:219], v[60:63]
    v_add_u32 v21, s21, v3
    s_mov_b32 s45, 0
    s_waitcnt vmcnt(0)
    s_branch L_p1_c
L_p1:
    buffer_load_dwordx4 v[136:139], v46, s[28:31], s18 offen offset:0 sc1
    buffer_load_dwordx4 v[140:143], v46, s[28:31], s18 offen offset:1024 sc1
    buffer_load_dwordx4 v[144:147], v46, s[28:31], s18 offen offset:2048 sc1
    buffer_load_dwordx4 v[148:151], v46, s[28:31], s18 offen offset:3072 sc1
    s_waitcnt vmcnt(0)
L_p1_c:
    v_xor_b32_e64 v12, s44, v139
    v_bitop3_b32 v12, v12, v143, v135 bitop3:0xf6
    v_bitop3_b32 v12, v12, v147, v135 bitop3:0xf6
    v_bitop3_b32 v12, v12, v151, v135 bitop3:0xf6
    v_cmp_ne_u32 vcc, 0, v12
    s_add_u32 s45, s45, 1
    s_cmp_ge_u32 s45, 200000
    s_cbranch_scc1 L_p1_d
    s_cbranch_vccnz L_p1
L_p1_d:
    v_mfma_f32_16x16x32_bf16 v[128:131], v[36:39], v[136:139], 0
    v_mfma_f32_16x16x32_bf16 v[128:131], v[36:39], v[140:143], v[128:131]
    v_mfma_f32_16x16x32_bf16 v[128:131], v[36:39], v[144:147], v[128:131]
    v_mfma_f32_16x16x32_bf16 v[128:131], v[36:39], v[148:151], v[128:131]
    s_nop 0
    s_nop 7
    v_cvt_pk_bf16_f32 v132, v128, v129
    v_cvt_pk_bf16_f32 v133, v130, v131
    s_nop 0
    v_permlane16_swap_b32 v132, v134
    s_mov_b64 exec, 0xffff
    buffer_store_dwordx4 v[132:135], v9, s[28:31], s22 offen sc1
    s_mov_b64 exec, 15
    buffer_atomic_swap v135, v13, s[28:31], s17 offen
    s_mov_b64 exec, -1
    ds_read_b64_tr_b16 v[104:105], v16 offset:4096
    v_mfma_f32_16x16x32_bf16 v[76:79], v[108:111], v[220:223], v[76:79]
    ds_read_b64_tr_b16 v[106:107], v16 offset:4608
    s_waitcnt lgkmcnt(12)
    v_mfma_f32_16x16x32_bf16 v[48:51], v[80:83], v[224:227], v[48:51]
    ds_read_b64_tr_b16 v[108:109], v17 offset:4096
    v_mfma_f32_16x16x32_bf16 v[64:67], v[80:83], v[228:231], v[64:67]
    ds_read_b64_tr_b16 v[110:111], v17 offset:4608
    s_waitcnt lgkmcnt(12)
    v_mfma_f32_16x16x32_bf16 v[52:55], v[84:87], v[224:227], v[52:55]
    ds_read_b64_tr_b16 v[80:81], v14 offset:8192
    v_mfma_f32_16x16x32_bf16 v[68:71], v[84:87], v[228:231], v[68:71]
    ds_read_b64_tr_b16 v[82:83], v14 offset:8704
    s_waitcnt lgkmcnt(12)
    v_mfma_f32_16x16x32_bf16 v[56:59], v[88:91], v[224:227], v[56:59]
    ds_read_b64_tr_b16 v[84:85], v15 offset:8192
    v_mfma_f32_16x16x32_bf16 v[72:75], v[88:91], v[228:231], v[72:75]
    ds_read_b64_tr_b16 v[86:87], v15 offset:8704
    s_waitcnt lgkmcnt(12)
    v_mfma_f32_16x16x32_bf16 v[60:63], v[92:95], v[224:227], v[60:63]
    ds_read_b64_tr_b16 v[88:89], v16 offset:8192
    v_mfma_f32_16x16x32_bf16 v[76:79], v[92:95], v[228:231], v[76:79]
    ds_read_b64_tr_b16 v[90:91], v16 offset:8704
    s_waitcnt lgkmcnt(12)
    v_mfma_f32_16x16x32_bf16 v[48:51], v[96:99], v[232:235], v[48:51]
    ds_read_b64_tr_b16 v[92:93], v17 offset:8192
    v_mfma_f32_16x16x32_bf16 v[64:67], v[96:99], v[236:239], v[64:67]
    ds_read_b64_tr_b16 v[94:95], v17 offset:8704
    s_waitcnt lgkmcnt(12)
    v_mfma_f32_16x16x32_bf16 v[52:55], v[100:103], v[232:235], v[52:55]
    s_barrier
    s_add_u32 m0, s56, 98304
    s_mov_b32 s59, 1048576
    buffer_load_dwordx4 v18, s[32:35], s59 offen offset:0 lds
    ds_read_b64_tr_b16 v[96:97], v14 offset:12288
    v_mfma_f32_16x16x32_bf16 v[68:71], v[100:103], v[236:239], v[68:71]
    ds_read_b64_tr_b16 v[98:99], v14 offset:12800
    s_waitcnt lgkmcnt(12)
    v_mfma_f32_16x16x32_bf16 v[56:59], v[104:107], v[232:235], v[56:59]
    buffer_load_dwordx4 v19, s[32:35], s59 offen offset:1024 lds
    ds_read_b64_tr_b16 v[100:101], v15 offset:12288
    v_mfma_f32_16x16x32_bf16 v[72:75], v[104:107], v[236:239], v[72:75]
    ds_read_b64_tr_b16 v[102:103], v15 offset:12800
    s_waitcnt lgkmcnt(12)
    v_mfma_f32_16x16x32_bf16 v[60:63], v[108:111], v[232:235], v[60:63]
    s_add_u32 m0, s56, 106496
    s_mov_b32 s59, 1179648
    buffer_load_dwordx4 v18, s[32:35], s59 offen offset:0 lds
    ds_read_b64_tr_b16 v[104:105], v16 offset:12288
    v_mfma_f32_16x16x32_bf16 v[76:79], v[108:111], v[236:239], v[76:79]
    ds_read_b64_tr_b16 v[106:107], v16 offset:12800
    s_waitcnt lgkmcnt(12)
    v_mfma_f32_16x16x32_bf16 v[48:51], v[80:83], v[240:243], v[48:51]
    buffer_load_dwordx4 v19, s[32:35], s59 offen offset:1024 lds
    ds_read_b64_tr_b16 v[108:109], v17 offset:12288
    v_mfma_f32_16x16x32_bf16 v[64:67], v[80:83], v[244:247], v[64:67]
    ds_read_b64_tr_b16 v[110:111], v17 offset:12800
    s_waitcnt lgkmcnt(12)
    v_mfma_f32_16x16x32_bf16 v[52:55], v[84:87], v[240:243], v[52:55]
    s_add_u32 m0, s56, 114688
    s_mov_b32 s59, 1310720
    buffer_load_dwordx4 v18, s[32:35], s59 offen offset:0 lds
    v_mfma_f32_16x16x32_bf16 v[68:71], v[84:87], v[244:247], v[68:71]
    s_waitcnt lgkmcnt(10)
    v_mfma_f32_16x16x32_bf16 v[56:59], v[88:91], v[240:243], v[56:59]
    buffer_load_dwordx4 v19, s[32:35], s59 offen offset:1024 lds
    v_mfma_f32_16x16x32_bf16 v[72:75], v[88:91], v[244:247], v[72:75]
    s_waitcnt lgkmcnt(8)
    v_mfma_f32_16x16x32_bf16 v[60:63], v[92:95], v[240:243], v[60:63]
    s_add_u32 m0, s56, 122880
    s_mov_b32 s59, 1441792
    buffer_load_dwordx4 v18, s[32:35], s59 offen offset:0 lds
    v_mfma_f32_16x16x32_bf16 v[76:79], v[92:95], v[244:247], v[76:79]
    s_waitcnt lgkmcnt(6)
    v_mfma_f32_16x16x32_bf16 v[48:51], v[96:99], v[248:251], v[48:51]
    buffer_load_dwordx4 v19, s[32:35], s59 offen offset:1024 lds
    v_mfma_f32_16x16x32_bf16 v[64:67], v[96:99], v[252:255], v[64:67]
    s_waitcnt lgkmcnt(4)
    v_mfma_f32_16x16x32_bf16 v[52:55], v[100:103], v[248:251], v[52:55]
    v_mfma_f32_16x16x32_bf16 v[68:71], v[100:103], v[252:255], v[68:71]
    s_waitcnt lgkmcnt(2)
    v_mfma_f32_16x16x32_bf16 v[56:59], v[104:107], v[248:251], v[56:59]
    v_mfma_f32_16x16x32_bf16 v[72:75], v[104:107], v[252:255], v[72:75]
    s_waitcnt lgkmcnt(0)
    v_mfma_f32_16x16x32_bf16 v[60:63], v[108:111], v[248:251], v[60:63]
    v_mfma_f32_16x16x32_bf16 v[76:79], v[108:111], v[252:255], v[76:79]
    ds_write_b128 v45, v[48:51] offset:0
    ds_write_b128 v45, v[64:67] offset:4096
    ds_write_b128 v45, v[52:55] offset:1024
    ds_write_b128 v45, v[68:71] offset:5120
    ds_write_b128 v45, v[56:59] offset:2048
    ds_write_b128 v45, v[72:75] offset:6144
    s_nop 0
    ds_write_b128 v45, v[60:63] offset:3072
    ds_write_b128 v45, v[76:79] offset:7168
    s_waitcnt lgkmcnt(0)
    s_barrier
    buffer_load_dwordx4 v[136:139], v9, s[28:31], s24 offen offset:0 sc1
    buffer_load_dwordx4 v[140:143], v9, s[28:31], s24 offen offset:1024 sc1
    buffer_load_dwordx4 v[144:147], v9, s[28:31], s24 offen offset:2048 sc1
    buffer_load_dwordx4 v[148:151], v9, s[28:31], s24 offen offset:3072 sc1
    s_add_u32 m0, s56, 131072
    s_mov_b32 s59, 1572864
    buffer_load_dwordx4 v18, s[32:35], s59 offen offset:0 lds
    buffer_load_dwordx4 v19, s[32:35], s59 offen offset:1024 lds
    s_add_u32 m0, s56, 139264
    s_mov_b32 s59, 1703936
    buffer_load_dwordx4 v18, s[32:35], s59 offen offset:0 lds
    buffer_load_dwordx4 v19, s[32:35], s59 offen offset:1024 lds
    ds_write_b32 v8, v2 offset:8480
    ds_write_b32 v8, v22 offset:8768
    s_add_u32 m0, s56, 147456
    s_mov_b32 s59, 1835008
    buffer_load_dwordx4 v18, s[32:35], s59 offen offset:0 lds
    buffer_load_dwordx4 v19, s[32:35], s59 offen offset:1024 lds
    s_add_u32 m0, s56, 32768
    s_mov_b32 s59, 0
    buffer_load_dwordx4 v18, s[32:35], s59 offen offset:0 lds
    buffer_load_dwordx4 v19, s[32:35], s59 offen offset:1024 lds
    s_mov_b32 s45, 0
    s_waitcnt vmcnt(8)
    s_branch L_p2_c
L_p2r:
    s_mov_b32 s45, 0
    s_mov_b64 exec, 0xffff
L_f2:
    v_mov_b32 v12, 0
    buffer_atomic_or v12, v8, s[28:31], s20 offen sc0
    s_waitcnt vmcnt(0)
    v_cmp_ne_u32 vcc, s44, v12
    s_add_u32 s45, s45, 1
    s_cmp_ge_u32 s45, 200000
    s_cbranch_scc1 L_f2_d
    s_cbranch_vccnz L_f2
L_f2_d:
    s_mov_b64 exec, -1
    buffer_load_dwordx4 v[136:139], v9, s[28:31], s24 offen offset:0 sc1
    buffer_load_dwordx4 v[140:143], v9, s[28:31], s24 offen offset:1024 sc1
    buffer_load_dwordx4 v[144:147], v9, s[28:31], s24 offen offset:2048 sc1
    buffer_load_dwordx4 v[148:151], v9, s[28:31], s24 offen offset:3072 sc1
    s_mov_b32 s45, 1
    s_waitcnt vmcnt(0)
    s_branch L_p2_c
L_p2x:
    s_cmp_eq_u32 s45, 1
    s_cbranch_scc1 L_p2r
L_p2:
    buffer_load_dwordx4 v[136:139], v9, s[28:31], s24 offen offset:0 sc1
    buffer_load_dwordx4 v[140:143], v9, s[28:31], s24 offen offset:1024 sc1
    buffer_load_dwordx4 v[144:147], v9, s[28:31], s24 offen offset:2048 sc1
    buffer_load_dwordx4 v[148:151], v9, s[28:31], s24 offen offset:3072 sc1
    s_waitcnt vmcnt(0)
L_p2_c:
    v_xor_b32_e64 v12, s44, v139
    v_bitop3_b32 v12, v12, v143, v135 bitop3:0xf6
    v_bitop3_b32 v12, v12, v147, v135 bitop3:0xf6
    v_bitop3_b32 v12, v12, v151, v135 bitop3:0xf6
    v_cmp_ne_u32 vcc, 0, v12
    s_add_u32 s45, s45, 1
    s_cmp_ge_u32 s45, 200000
    s_cbranch_scc1 L_p2x_d
    s_cbranch_vccnz L_p2x
L_p2x_d:
    ds_write_b64 v20, v[136:137] offset:0
    ds_write_b16 v21, v138 offset:0
    ds_write_b64 v20, v[140:141] offset:256
    ds_write_b16 v21, v142 offset:32
    ds_write_b64 v20, v[144:145] offset:512
    ds_write_b64 v20, v[148:149] offset:768
    s_add_u32 m0, s56, 40960
    s_mov_b32 s59, 131072
    buffer_load_dwordx4 v18, s[32:35], s59 offen offset:0 lds
    buffer_load_dwordx4 v19, s[32:35], s59 offen offset:1024 lds
    s_add_u32 m0, s56, 81920
    s_mov_b32 s59, 786432
    buffer_load_dwordx4 v18, s[32:35], s59 offen offset:0 lds
    buffer_load_dwordx4 v19, s[32:35], s59 offen offset:1024 lds
    s_add_u32 m0, s56, 90112
    s_mov_b32 s59, 917504
    buffer_load_dwordx4 v18, s[32:35], s59 offen offset:0 lds
    buffer_load_dwordx4 v19, s[32:35], s59 offen offset:1024 lds
    s_waitcnt lgkmcnt(0)
    s_barrier
    s_add_u32 m0, s56, 155648
    s_mov_b32 s59, 1966080
    buffer_load_dwordx4 v18, s[32:35], s59 offen offset:0 lds
    buffer_load_dwordx4 v19, s[32:35], s59 offen offset:1024 lds
    s_add_u32 m0, s56, 49152
    s_mov_b32 s59, 262144
    buffer_load_dwordx4 v18, s[32:35], s59 offen offset:0 lds
    buffer_load_dwordx4 v19, s[32:35], s59 offen offset:1024 lds
    s_add_u32 m0, s56, 57344
    s_mov_b32 s59, 393216
    buffer_load_dwordx4 v18, s[32:35], s59 offen offset:0 lds
    buffer_load_dwordx4 v19, s[32:35], s59 offen offset:1024 lds
    s_add_u32 m0, s56, 65536
    s_mov_b32 s59, 524288
    buffer_load_dwordx4 v18, s[32:35], s59 offen offset:0 lds
    buffer_load_dwordx4 v19, s[32:35], s59 offen offset:1024 lds
    s_add_u32 m0, s56, 73728
    s_mov_b32 s59, 655360
    buffer_load_dwordx4 v18, s[32:35], s59 offen offset:0 lds
    buffer_load_dwordx4 v19, s[32:35], s59 offen offset:1024 lds
    s_mov_b32 s47, 0
    s_branch L_G2
L_stub:
L_last:
.section .rodata,"a"
.p2align 6
.amdhsa_kernel standalone__linear_kernel_hedgehog__prompt_kernel
  .amdhsa_next_free_vgpr 256
  .amdhsa_next_free_sgpr 64
  .amdhsa_accum_offset 256
  .amdhsa_group_segment_fixed_size 0
  .amdhsa_kernarg_size 56
  .amdhsa_user_sgpr_count 2
  .amdhsa_user_sgpr_kernarg_segment_ptr 1
  .amdhsa_system_sgpr_workgroup_id_x 1
.end_amdhsa_kernel
```
